```python
import torch

def _softmax(x, axis=-1):
    return torch.softmax(x, dim=axis)
def _gelu(x):
    return torch.nn.functional.gelu(x, approximate="tanh")
def _silu(x):
    return torch.nn.functional.silu(x)
def _sigmoid(x):
    return torch.sigmoid(x)
def _layernorm(x, axis=-1, eps=1e-5):
    m = x.mean(dim=axis, keepdim=True)
    v = x.var(dim=axis, keepdim=True, unbiased=False)
    return (x - m) / torch.sqrt(v + eps)
def _scatter_add(tgt, idx, src, axis=0):
    return tgt.clone().index_add_(axis, idx, src)
def _segment_sum(src, seg, n):
    out = torch.zeros((n,) + src.shape[1:], dtype=src.dtype)
    return out.index_add_(0, seg, src)
def _pad(x, pw):
    flat = tuple(v for pair in reversed(pw) for v in pair)
    return torch.nn.functional.pad(x, flat)

kernel_name = 'standalone__paged_block_table_kv_radixattention__decode'

def setup_inputs():

    _w = (lambda a: (lambda t: t.to(torch.bfloat16) if t.is_floating_point() else t)(torch.as_tensor(a)))
    B, H, Hkv, Dh = 2, 32, 4, 128
    Lk = 32768
    bs = 16
    nb = max(2, Lk // bs)
    P = max(1, nb // 2)
    n_phys = P + B * (nb - P)
    shared = torch.arange(P, dtype=torch.int64)
    priv = P + torch.arange(B * (nb - P), dtype=torch.int64).reshape(B, nb - P)
    bt = torch.cat([torch.tile(shared[None, :], (B, 1)), priv], dim=1)
    ctx = nb * bs - (torch.arange(1, B + 1, dtype=torch.int64) * 2654435761) % max(1, (nb * bs - P * bs) // 2)
    return {
        "q": _w((lambda *s: torch.randn(*s, dtype=torch.bfloat16) * 0.8)(B, H, Dh)),
        "k_cache": _w((lambda *s: torch.randn(*s, dtype=torch.bfloat16) * 0.8)(n_phys, bs, Hkv, Dh)),
        "v_cache": _w((lambda *s: torch.randn(*s, dtype=torch.bfloat16) * 0.05)(n_phys, bs, Hkv, Dh)),
        "block_table": _w(bt.to(torch.int64)),
        "ctx_lens": _w(torch.as_tensor(ctx).to(torch.int64)),
    }

def reference(q, k_cache, v_cache, block_table, ctx_lens):
    B, H, Dh = q.shape
    n_phys, bs, Hkv, _ = k_cache.shape
    nb = block_table.shape[1]
    Lk = nb * bs
    rep = H // Hkv
    k = k_cache[block_table].reshape(B, Lk, Hkv, Dh)
    v = v_cache[block_table].reshape(B, Lk, Hkv, Dh)
    k = (lambda x, n, axis: torch.repeat_interleave(x, n, dim=axis))(k, rep, axis=2)
    v = (lambda x, n, axis: torch.repeat_interleave(x, n, dim=axis))(v, rep, axis=2)
    scores = torch.einsum("bhd,bkhd->bhk", q, k) * (Dh ** -0.5)
    pos = torch.arange(Lk)
    valid = pos[None, :] < ctx_lens[:, None]
    scores = torch.where(valid[:, None, :], scores, -1e9)
    p = _softmax(scores, axis=-1)
    return torch.einsum("bhk,bkhd->bhd", p, v)
```

```asm
; @launch grid=(256,1,1) block=(256,1,1) lds=163840
.amdgcn_target "amdgcn-amd-amdhsa--gfx950"
.text
    .globl standalone__paged_block_table_kv_radixattention__decode_kernel
    .p2align 8
    .type standalone__paged_block_table_kv_radixattention__decode_kernel,@function
standalone__paged_block_table_kv_radixattention__decode_kernel:
    s_load_dwordx16 s[4:19], s[0:1], 0
    s_cmp_ge_u32 s2, 256
    s_cbranch_scc1 L_end
    v_lshrrev_b32 v16, 6, v0
    s_lshr_b32 s31, s2, 2
    s_getpc_b64 s[84:85]
    s_lshr_b32 s36, s2, 3
    v_lshl_add_u32 v17, s36, 2, v16
    v_lshlrev_b32 v17, 7, v17
    v_min_u32 v17, L_codeend-standalone__paged_block_table_kv_radixattention__decode_kernel-128, v17
    global_load_dword v253, v17, s[84:85]
    s_mul_i32 s37, s31, 60
    v_readfirstlane_b32 s3, v16
    s_waitcnt lgkmcnt(0)
    s_load_dwordx16 s[44:59], s[10:11], s37
    s_load_dwordx2 s[28:29], s[12:13], 0
    s_and_b32 s30, s2, 3
    s_sub_u32 s36, s31, 40
    s_cmp_lt_u32 s36, 1
    s_cselect_b32 s43, 1, 7
    s_cmp_eq_u32 s3, s43
    s_cbranch_scc1 L_reset
L_resetd:
    s_lshl_b32 s36, s30, 18
    s_lshl_b32 s37, s31, 9
    s_add_u32 s36, s36, s37
    v_and_b32 v18, 31, v0
    v_lshrrev_b32 v19, 5, v0
    v_lshl_add_u32 v254, v18, 4, s36
    v_lshl_add_u32 v254, v19, 15, v254
    global_load_dwordx4 v[216:219], v254, s[18:19] sc1
    v_and_b32 v1, 63, v0
    v_and_b32 v20, 15, v0
    v_bfe_u32 v21, v0, 4, 2
    s_lshl_b32 s36, s30, 8
    s_lshl_b32 s41, s3, 10
    s_add_u32 s36, s36, s41
    v_lshl_add_u32 v22, v21, 12, s36
    v_lshlrev_b32 v29, 2, v21
    v_xor_b32 v32, v29, v20
    s_mul_i32 s41, s3, 40960
    v_lshl_add_u32 v2, v32, 4, v22
    v_xor_b32 v33, 1, v32
    v_lshl_add_u32 v3, v33, 4, v22
    v_xor_b32 v34, 2, v32
    v_lshl_add_u32 v4, v34, 4, v22
    v_xor_b32 v35, 3, v32
    v_lshl_add_u32 v5, v35, 4, v22
    s_mov_b32 s20, s6
    s_mov_b32 s21, s7
    s_mov_b32 s22, 50331648
    s_mov_b32 s23, 0x20000
    s_lshl_b32 s36, s30, 11
    v_lshrrev_b32 v26, 1, v21
    v_and_b32 v28, 1, v21
    v_lshl_add_u32 v27, v26, 13, s36
    v_lshl_add_u32 v27, v28, 10, v27
    s_mov_b32 s24, s4
    s_mov_b32 s25, s5
    s_mov_b32 s26, 16384
    s_mov_b32 s27, 0x20000
    s_add_u32 m0, s41, 36864
    v_lshl_add_u32 v32, v32, 4, v27
    buffer_load_dwordx4 v32, s[24:27], 0 offen offset:0 lds
    s_add_u32 m0, s41, 37632
    v_lshl_add_u32 v33, v33, 4, v27
    buffer_load_dwordx4 v33, s[24:27], 0 offen offset:256 lds
    s_add_u32 m0, s41, 38400
    v_lshl_add_u32 v34, v34, 4, v27
    buffer_load_dwordx4 v34, s[24:27], 0 offen offset:512 lds
    s_add_u32 m0, s41, 39168
    v_lshl_add_u32 v35, v35, 4, v27
    buffer_load_dwordx4 v35, s[24:27], 0 offen offset:768 lds
    s_sub_u32 s36, 63, s31
    v_mov_b32 v18, s36
    s_mov_b32 exec_hi, 0
    v_mov_b32 v18, s31
    s_mov_b64 exec, -1
    v_and_b32 v17, 31, v0
    v_lshl_add_u32 v17, v17, 6, v18
    s_mov_b32 exec_lo, 0x7fff
    s_mov_b32 exec_hi, 0x7fff
    v_mad_u32_u24 v17, v18, 15, v20
    s_mov_b64 exec, -1
    v_lshlrev_b32 v18, 2, v17
    v_lshlrev_b32 v17, 4, v17
    v_add_u32 v19, 0x2000, v18
    global_load_dword v24, v18, s[10:11]
    global_load_dword v25, v19, s[10:11]
    s_mov_b32 m0, s41
    s_waitcnt lgkmcnt(0)
    s_lshl_b32 s44, s44, 14
    buffer_load_dwordx4 v2, s[20:23], s44 offen nt lds
    s_add_u32 m0, s41, 1024
    s_lshl_b32 s45, s45, 14
    buffer_load_dwordx4 v3, s[20:23], s45 offen nt lds
    s_add_u32 m0, s41, 2048
    s_lshl_b32 s46, s46, 14
    buffer_load_dwordx4 v4, s[20:23], s46 offen nt lds
    s_add_u32 m0, s41, 3072
    s_lshl_b32 s47, s47, 14
    buffer_load_dwordx4 v5, s[20:23], s47 offen nt lds
    s_add_u32 m0, s41, 4096
    s_lshl_b32 s48, s48, 14
    buffer_load_dwordx4 v2, s[20:23], s48 offen nt lds
    s_add_u32 m0, s41, 5120
    s_lshl_b32 s49, s49, 14
    buffer_load_dwordx4 v3, s[20:23], s49 offen nt lds
    s_lshl_b32 s50, s50, 14
    s_lshl_b32 s51, s51, 14
    s_lshl_b32 s52, s52, 14
    s_lshl_b32 s53, s53, 14
    s_lshl_b32 s54, s54, 14
    s_lshl_b32 s55, s55, 14
    s_lshl_b32 s56, s56, 14
    s_lshl_b32 s57, s57, 14
    s_lshl_b32 s58, s58, 14
    s_mov_b32 s24, s8
    s_mov_b32 s25, s9
    s_mov_b32 s26, 50331648
    s_mov_b32 s27, 0x20000
    s_mov_b32 s38, 0x05040100
    s_mov_b32 s39, 0x07060302
    s_mov_b32 s40, 0x3e0293ee
    s_mov_b32 s33, 0
    s_mov_b32 s96, 4194304
    v_lshl_add_u32 v10, v20, 4, v22
    v_lshrrev_b32 v26, 3, v20
    v_mul_u32_u24 v11, 5, v26
    v_lshl_add_u32 v12, v21, 2, s3
    v_and_b32 v23, 3, v20
    v_lshrrev_b32 v28, 2, v20
    v_lshl_add_u32 v23, v23, 2, v28
    v_lshl_add_u32 v23, v23, 8, s41
    v_xor_b32 v29, v21, v20
    v_xor_b32 v28, 0, v29
    v_lshl_add_u32 v6, v28, 4, v23
    v_xor_b32 v28, 4, v29
    v_lshl_add_u32 v7, v28, 4, v23
    v_xor_b32 v28, 8, v29
    v_lshl_add_u32 v8, v28, 4, v23
    v_xor_b32 v28, 12, v29
    v_lshl_add_u32 v9, v28, 4, v23
    s_cmp_lt_i32 s28, 1
    s_cselect_b32 s42, 0x00ff00ff, 0
    s_cselect_b32 s28, 0x8000, s28
    s_cmp_lt_i32 s29, 1
    s_cselect_b32 s36, 0xff00ff00, 0
    s_cselect_b32 s29, 0x8000, s29
    s_or_b32 s42, s42, s36
    v_sub_u32 v30, s28, v17
    v_sub_u32 v31, s29, v17
    v_med3_i32 v30, v30, 0, 16
    v_med3_i32 v31, v31, 0, 16
    s_mov_b32 s84, -1
    s_mov_b32 s85, 0
    v_cmp_lt_i32 s[86:87], 0, v30
    v_cmp_lt_i32 s[88:89], 0, v31
    v_cndmask_b32 v30, 0, v30, s[84:85]
    v_mov_b32 v29, 0x40000000
    v_mov_b32 v13, 0xff800000
    v_mov_b32 v14, 0xf149f2ca
    v_mov_b32 v28, 0x3f803f80
    s_cmp_eq_u32 s30, 1
    s_cselect_b64 vcc, -1, 0
    v_accvgpr_write_b32 a84, v28
    v_accvgpr_write_b32 a85, v28
    v_accvgpr_write_b32 a86, v28
    v_accvgpr_write_b32 a87, v28
    v_accvgpr_write_b32 a48, 0
    v_accvgpr_write_b32 a49, 0
    v_accvgpr_write_b32 a50, 0
    v_accvgpr_write_b32 a51, 0
    v_accvgpr_write_b32 a52, 0
    v_accvgpr_write_b32 a53, 0
    v_accvgpr_write_b32 a54, 0
    v_accvgpr_write_b32 a55, 0
    v_accvgpr_write_b32 a56, 0
    v_accvgpr_write_b32 a57, 0
    v_accvgpr_write_b32 a58, 0
    v_accvgpr_write_b32 a59, 0
    v_accvgpr_write_b32 a60, 0
    v_accvgpr_write_b32 a61, 0
    v_accvgpr_write_b32 a62, 0
    v_accvgpr_write_b32 a63, 0
    v_accvgpr_write_b32 a64, 0
    v_accvgpr_write_b32 a65, 0
    v_accvgpr_write_b32 a66, 0
    v_accvgpr_write_b32 a67, 0
    v_accvgpr_write_b32 a68, 0
    v_accvgpr_write_b32 a69, 0
    v_accvgpr_write_b32 a70, 0
    v_accvgpr_write_b32 a71, 0
    v_accvgpr_write_b32 a72, 0
    v_accvgpr_write_b32 a73, 0
    v_accvgpr_write_b32 a74, 0
    v_accvgpr_write_b32 a75, 0
    v_accvgpr_write_b32 a76, 0
    v_accvgpr_write_b32 a77, 0
    v_accvgpr_write_b32 a78, 0
    v_accvgpr_write_b32 a79, 0
    v_accvgpr_write_b32 a80, 0
    v_accvgpr_write_b32 a81, 0
    v_accvgpr_write_b32 a82, 0
    v_accvgpr_write_b32 a83, 0
    s_cmp_lg_u32 s3, s43
    s_cbranch_scc1 L_noflag
    s_waitcnt vmcnt(13)
    s_and_b32 s36, s31, 7
    s_lshl4_add_u32 s36, s30, s36
    s_lshl_b32 s36, s36, 2
    v_mov_b32 v240, s36
    v_mov_b32 v241, 1
    s_mov_b64 exec, 1
    global_store_dword v240, v241, s[16:17] sc1
    s_mov_b64 exec, -1
L_noflag:
    s_add_u32 m0, s41, 6144
    s_waitcnt vmcnt(8)
    s_cbranch_vccnz L_p1
    s_waitcnt vmcnt(5)
L_p1:
    buffer_load_dwordx4 v4, s[20:23], s50 offen nt lds
    s_add_u32 m0, s41, 7168
    s_waitcnt vmcnt(8)
    s_cbranch_vccnz L_p2
    s_waitcnt vmcnt(5)
L_p2:
    buffer_load_dwordx4 v5, s[20:23], s51 offen nt lds
    s_add_u32 m0, s41, 8192
    s_waitcnt vmcnt(8)
    s_cbranch_vccnz L_p3
    s_waitcnt vmcnt(4)
L_p3:
    buffer_load_dwordx4 v2, s[20:23], s52 offen nt lds
    s_add_u32 m0, s41, 9216
    s_waitcnt vmcnt(8)
    s_cbranch_vccnz L_p4
    s_waitcnt vmcnt(4)
L_p4:
    buffer_load_dwordx4 v3, s[20:23], s53 offen nt lds
    s_add_u32 m0, s41, 10240
    s_waitcnt vmcnt(8)
    s_cbranch_vccnz L_p5
    s_waitcnt vmcnt(4)
L_p5:
    buffer_load_dwordx4 v4, s[20:23], s54 offen nt lds
    s_add_u32 m0, s41, 11264
    s_waitcnt vmcnt(8)
    s_cbranch_vccnz L_p6
    s_waitcnt vmcnt(4)
L_p6:
    buffer_load_dwordx4 v5, s[20:23], s55 offen nt lds
    s_add_u32 m0, s41, 12288
    s_waitcnt vmcnt(8)
    s_cbranch_vccnz L_p7
    s_waitcnt vmcnt(4)
L_p7:
    buffer_load_dwordx4 v2, s[20:23], s56 offen nt lds
    v_cmp_eq_u32 s[92:93], v24, v25
    v_cndmask_b32 v24, v25, v24, s[84:85]
    v_lshl_add_u32 v24, v24, 14, v30
    s_and_b64 s[92:93], s[92:93], s[86:87]
    s_xnor_b64 s[90:91], s[92:93], s[84:85]
    s_andn2_b64 s[88:89], s[88:89], s[92:93]
    v_cndmask_b32 v31, 0, v31, s[90:91]
    s_mov_b32 s88, s86
    v_lshl_add_u32 v24, v31, 5, v24
    v_cndmask_b32 v24, v29, v24, s[88:89]
    s_or_b32 s88, s88, 0x7fff
    s_bcnt1_i32_b64 s32, s[88:89]
    v_mbcnt_lo_u32_b32 v25, s88, 0
    v_mbcnt_hi_u32_b32 v25, s89, v25
    v_sub_u32 v26, v1, v25
    v_add_u32 v26, s32, v26
    s_mul_i32 s37, s31, 17
    s_and_b32 s37, s37, 63
    s_sub_u32 s36, s32, 15
    s_mul_i32 s37, s37, s36
    s_lshr_b32 s37, s37, 6
    s_mov_b32 exec_lo, 0xffff8000
    v_subrev_u32 v25, s37, v25
    v_cmp_gt_i32 s[92:93], 15, v25
    v_add_u32 v27, s36, v25
    s_nop 0
    v_cndmask_b32 v25, v25, v27, s[92:93]
    s_mov_b32 exec_lo, -1
    v_cndmask_b32 v25, v26, v25, s[88:89]
    v_lshlrev_b32 v25, 2, v25
    ds_permute_b32 v252, v25, v24
    ds_read_b128 a[0:3], v6 offset:36864
    ds_read_b128 a[4:7], v7 offset:36864
    ds_read_b128 a[8:11], v8 offset:36864
    ds_read_b128 a[12:15], v9 offset:36864
    s_add_u32 m0, s41, 13312
    s_waitcnt vmcnt(8)
    s_cbranch_vccnz L_p8
    s_waitcnt vmcnt(4)
L_p8:
    buffer_load_dwordx4 v3, s[20:23], s57 offen nt lds
    v_not_b32 v26, v216
    v_not_b32 v27, v218
    v_and_b32 v26, 1, v26
    v_and_b32 v27, 1, v27
    v_accvgpr_write_b32 a88, v26
    v_accvgpr_write_b32 a89, v27
    s_waitcnt lgkmcnt(0)
    v_and_b32 v255, 0xffffc000, v252
    s_cmp_lg_u32 s42, 0
    s_cbranch_scc1 L_ctx0
L_ctxok:
L_body:
    s_cmp_le_u32 s32, 40
    s_cselect_b32 s34, 0, 7
    v_readlane_b32 s59, v255, 15
    v_readlane_b32 s60, v255, 16
    v_readlane_b32 s61, v255, 17
    v_readlane_b32 s62, v255, 18
    v_readlane_b32 s63, v255, 19
    v_readlane_b32 s64, v255, 20
    v_readlane_b32 s65, v255, 21
    v_readlane_b32 s66, v255, 22
    v_readlane_b32 s67, v255, 23
    s_add_u32 m0, s41, 14336
    s_waitcnt vmcnt(8)
    s_cbranch_vccnz L_p9
    s_waitcnt vmcnt(4)
L_p9:
    buffer_load_dwordx4 v4, s[20:23], s58 offen nt lds
    ds_read_b128 a[16:19], v6 offset:0
    ds_read_b128 a[20:23], v7 offset:0
    ds_read_b128 a[24:27], v8 offset:0
    ds_read_b128 a[28:31], v9 offset:0
    s_add_u32 m0, s41, 15360
    s_waitcnt vmcnt(8)
    s_cbranch_vccnz L_p10
    s_waitcnt vmcnt(4)
L_p10:
    buffer_load_dwordx4 v5, s[20:23], s59 offen nt lds
    v_readlane_b32 s68, v255, 24
    v_readlane_b32 s69, v255, 25
    v_readlane_b32 s70, v255, 26
    v_readlane_b32 s71, v255, 27
    v_readlane_b32 s72, v255, 28
    v_readlane_b32 s73, v255, 29
    v_readlane_b32 s74, v255, 30
    v_readlane_b32 s75, v255, 31
    s_waitcnt lgkmcnt(0)
    v_mfma_f32_16x16x32_bf16 v[176:179], a[16:19], a[0:3], 0
    v_mfma_f32_16x16x32_bf16 v[176:179], a[20:23], a[4:7], v[176:179]
    v_mfma_f32_16x16x32_bf16 v[176:179], a[24:27], a[8:11], v[176:179]
    v_mfma_f32_16x16x32_bf16 v[176:179], a[28:31], a[12:15], v[176:179]
    s_add_u32 m0, s41, 16384
    s_waitcnt vmcnt(8)
    s_cbranch_vccnz L_p11
    s_waitcnt vmcnt(4)
L_p11:
    buffer_load_dwordx4 v2, s[20:23], s60 offen nt lds
    v_readlane_b32 s92, v252, 0
    v_readlane_b32 s93, v252, 1
    v_readlane_b32 s94, v252, 2
    v_readlane_b32 s95, v252, 3
    v_bfe_u32 v236, s92, v11, 5
    v_bfe_u32 v237, s93, v11, 5
    v_bfe_u32 v238, s94, v11, 5
    v_bfe_u32 v239, s95, v11, 5
    v_cmp_lt_u32 s[84:85], v12, v236
    v_cmp_lt_u32 s[86:87], v12, v237
    v_cmp_lt_u32 s[88:89], v12, v238
    v_cmp_lt_u32 s[90:91], v12, v239
    v_cndmask_b32 v176, v13, v176, s[84:85]
    v_cndmask_b32 v177, v13, v177, s[86:87]
    v_cndmask_b32 v178, v13, v178, s[88:89]
    v_cndmask_b32 v179, v13, v179, s[90:91]
    v_max3_f32 v15, v176, v177, v14
    v_max3_f32 v15, v178, v179, v15
    ds_read_b128 a[32:35], v6 offset:4096
    ds_read_b128 a[36:39], v7 offset:4096
    ds_read_b128 a[40:43], v8 offset:4096
    ds_read_b128 a[44:47], v9 offset:4096
    s_add_u32 m0, s41, 17408
    s_waitcnt vmcnt(8)
    s_cbranch_vccnz L_p12
    s_waitcnt vmcnt(4)
L_p12:
    buffer_load_dwordx4 v3, s[20:23], s61 offen nt lds
    s_waitcnt lgkmcnt(0)
    v_mfma_f32_16x16x32_bf16 v[180:183], a[32:35], a[0:3], 0
    v_mfma_f32_16x16x32_bf16 v[180:183], a[36:39], a[4:7], v[180:183]
    v_mfma_f32_16x16x32_bf16 v[180:183], a[40:43], a[8:11], v[180:183]
    v_mfma_f32_16x16x32_bf16 v[180:183], a[44:47], a[12:15], v[180:183]
    s_add_u32 m0, s41, 18432
    s_waitcnt vmcnt(8)
    s_cbranch_vccnz L_p13
    s_waitcnt vmcnt(4)
L_p13:
    buffer_load_dwordx4 v4, s[20:23], s62 offen nt lds
    v_readlane_b32 s92, v252, 4
    v_readlane_b32 s93, v252, 5
    v_readlane_b32 s94, v252, 6
    v_readlane_b32 s95, v252, 7
    v_bfe_u32 v236, s92, v11, 5
    v_bfe_u32 v237, s93, v11, 5
    v_bfe_u32 v238, s94, v11, 5
    v_bfe_u32 v239, s95, v11, 5
    v_cmp_lt_u32 s[84:85], v12, v236
    v_cmp_lt_u32 s[86:87], v12, v237
    v_cmp_lt_u32 s[88:89], v12, v238
    v_cmp_lt_u32 s[90:91], v12, v239
    v_cndmask_b32 v180, v13, v180, s[84:85]
    v_cndmask_b32 v181, v13, v181, s[86:87]
    v_cndmask_b32 v182, v13, v182, s[88:89]
    v_cndmask_b32 v183, v13, v183, s[90:91]
    v_max3_f32 v15, v180, v181, v15
    v_max3_f32 v15, v182, v183, v15
    s_add_u32 m0, s41, 19456
    s_waitcnt vmcnt(8)
    s_cbranch_vccnz L_p14
    s_waitcnt vmcnt(4)
L_p14:
    buffer_load_dwordx4 v5, s[20:23], s63 offen nt lds
    v_readlane_b32 s76, v255, 32
    v_readlane_b32 s77, v255, 33
    v_readlane_b32 s78, v255, 34
    v_readlane_b32 s79, v255, 35
    v_readlane_b32 s80, v255, 36
    v_readlane_b32 s81, v255, 37
    v_readlane_b32 s82, v255, 38
    v_readlane_b32 s83, v255, 39
    s_add_u32 m0, s41, 20480
    s_waitcnt vmcnt(8)
    s_cbranch_vccnz L_p15
    s_waitcnt vmcnt(4)
L_p15:
    buffer_load_dwordx4 v2, s[20:23], s64 offen nt lds
    ds_read_b128 a[16:19], v6 offset:8192
    ds_read_b128 a[20:23], v7 offset:8192
    ds_read_b128 a[24:27], v8 offset:8192
    ds_read_b128 a[28:31], v9 offset:8192
    s_add_u32 m0, s41, 21504
    s_waitcnt vmcnt(8)
    s_cbranch_vccnz L_p16
    s_waitcnt vmcnt(4)
L_p16:
    buffer_load_dwordx4 v3, s[20:23], s65 offen nt lds
    s_waitcnt lgkmcnt(0)
    v_mfma_f32_16x16x32_bf16 v[184:187], a[16:19], a[0:3], 0
    v_mfma_f32_16x16x32_bf16 v[184:187], a[20:23], a[4:7], v[184:187]
    v_mfma_f32_16x16x32_bf16 v[184:187], a[24:27], a[8:11], v[184:187]
    v_mfma_f32_16x16x32_bf16 v[184:187], a[28:31], a[12:15], v[184:187]
    s_add_u32 m0, s41, 22528
    s_waitcnt vmcnt(8)
    s_cbranch_vccnz L_p17
    s_waitcnt vmcnt(4)
L_p17:
    buffer_load_dwordx4 v4, s[20:23], s66 offen nt lds
    v_readlane_b32 s92, v252, 8
    v_readlane_b32 s93, v252, 9
    v_readlane_b32 s94, v252, 10
    v_readlane_b32 s95, v252, 11
    v_bfe_u32 v236, s92, v11, 5
    v_bfe_u32 v237, s93, v11, 5
    v_bfe_u32 v238, s94, v11, 5
    v_bfe_u32 v239, s95, v11, 5
    v_cmp_lt_u32 s[84:85], v12, v236
    v_cmp_lt_u32 s[86:87], v12, v237
    v_cmp_lt_u32 s[88:89], v12, v238
    v_cmp_lt_u32 s[90:91], v12, v239
    v_cndmask_b32 v184, v13, v184, s[84:85]
    v_cndmask_b32 v185, v13, v185, s[86:87]
    v_cndmask_b32 v186, v13, v186, s[88:89]
    v_cndmask_b32 v187, v13, v187, s[90:91]
    v_max3_f32 v15, v184, v185, v15
    v_max3_f32 v15, v186, v187, v15
    s_add_u32 m0, s41, 23552
    s_waitcnt vmcnt(8)
    s_cbranch_vccnz L_p18
    s_waitcnt vmcnt(4)
L_p18:
    buffer_load_dwordx4 v5, s[20:23], s67 offen nt lds
    v_readlane_b32 s44, v255, 0
    v_readlane_b32 s45, v255, 1
    v_readlane_b32 s46, v255, 2
    v_readlane_b32 s47, v255, 3
    v_readlane_b32 s48, v255, 4
    v_readlane_b32 s49, v255, 5
    v_readlane_b32 s50, v255, 6
    v_readlane_b32 s51, v255, 7
    v_readlane_b32 s52, v255, 8
    v_readlane_b32 s53, v255, 9
    v_readlane_b32 s54, v255, 10
    v_readlane_b32 s55, v255, 11
    v_readlane_b32 s56, v255, 12
    v_readlane_b32 s57, v255, 13
    v_readlane_b32 s58, v255, 14
    s_add_u32 m0, s41, 24576
    s_waitcnt vmcnt(8)
    s_cbranch_vccnz L_p19
    s_waitcnt vmcnt(4)
L_p19:
    buffer_load_dwordx4 v2, s[20:23], s68 offen nt lds
    ds_read_b128 a[32:35], v6 offset:12288
    ds_read_b128 a[36:39], v7 offset:12288
    ds_read_b128 a[40:43], v8 offset:12288
    ds_read_b128 a[44:47], v9 offset:12288
    s_add_u32 m0, s41, 25600
    s_waitcnt vmcnt(8)
    s_cbranch_vccnz L_p20
    s_waitcnt vmcnt(4)
L_p20:
    buffer_load_dwordx4 v3, s[20:23], s69 offen nt lds
    s_waitcnt lgkmcnt(0)
    v_mfma_f32_16x16x32_bf16 v[188:191], a[32:35], a[0:3], 0
    v_mfma_f32_16x16x32_bf16 v[188:191], a[36:39], a[4:7], v[188:191]
    v_mfma_f32_16x16x32_bf16 v[188:191], a[40:43], a[8:11], v[188:191]
    v_mfma_f32_16x16x32_bf16 v[188:191], a[44:47], a[12:15], v[188:191]
    s_add_u32 m0, s41, 26624
    s_waitcnt vmcnt(8)
    s_cbranch_vccnz L_p21
    s_waitcnt vmcnt(4)
L_p21:
    buffer_load_dwordx4 v4, s[20:23], s70 offen nt lds
    v_readlane_b32 s92, v252, 12
    v_readlane_b32 s93, v252, 13
    v_readlane_b32 s94, v252, 14
    v_readlane_b32 s95, v252, 15
    v_bfe_u32 v236, s92, v11, 5
    v_bfe_u32 v237, s93, v11, 5
    v_bfe_u32 v238, s94, v11, 5
    v_bfe_u32 v239, s95, v11, 5
    v_cmp_lt_u32 s[84:85], v12, v236
    v_cmp_lt_u32 s[86:87], v12, v237
    v_cmp_lt_u32 s[88:89], v12, v238
    v_cmp_lt_u32 s[90:91], v12, v239
    v_cndmask_b32 v188, v13, v188, s[84:85]
    v_cndmask_b32 v189, v13, v189, s[86:87]
    v_cndmask_b32 v190, v13, v190, s[88:89]
    v_cndmask_b32 v191, v13, v191, s[90:91]
    v_max3_f32 v15, v188, v189, v15
    v_max3_f32 v15, v190, v191, v15
    s_add_u32 m0, s41, 27648
    s_waitcnt vmcnt(8)
    s_cbranch_vccnz L_p22
    s_waitcnt vmcnt(4)
L_p22:
    buffer_load_dwordx4 v5, s[20:23], s71 offen nt lds
    v_mov_b32 v160, 0
    v_mov_b32 v161, 0
    v_mov_b32 v162, 0
    v_mov_b32 v163, 0
    v_mov_b32 v164, 0
    v_mov_b32 v165, 0
    v_mov_b32 v166, 0
    v_mov_b32 v167, 0
    v_mov_b32 v168, 0
    v_mov_b32 v169, 0
    v_mov_b32 v170, 0
    v_mov_b32 v171, 0
    v_mov_b32 v172, 0
    v_mov_b32 v173, 0
    v_mov_b32 v174, 0
    v_mov_b32 v175, 0
    s_add_u32 m0, s41, 28672
    s_waitcnt vmcnt(8)
    s_cbranch_vccnz L_p23
    s_waitcnt vmcnt(4)
L_p23:
    buffer_load_dwordx4 v2, s[20:23], s72 offen nt lds
    ds_read_b128 a[16:19], v6 offset:16384
    ds_read_b128 a[20:23], v7 offset:16384
    ds_read_b128 a[24:27], v8 offset:16384
    ds_read_b128 a[28:31], v9 offset:16384
    s_add_u32 m0, s41, 29696
    s_waitcnt vmcnt(8)
    s_cbranch_vccnz L_p24
    s_waitcnt vmcnt(4)
L_p24:
    buffer_load_dwordx4 v3, s[20:23], s73 offen nt lds
    s_waitcnt lgkmcnt(0)
    v_mfma_f32_16x16x32_bf16 v[192:195], a[16:19], a[0:3], 0
    v_mfma_f32_16x16x32_bf16 v[192:195], a[20:23], a[4:7], v[192:195]
    v_mfma_f32_16x16x32_bf16 v[192:195], a[24:27], a[8:11], v[192:195]
    v_mfma_f32_16x16x32_bf16 v[192:195], a[28:31], a[12:15], v[192:195]
    s_add_u32 m0, s41, 30720
    s_waitcnt vmcnt(8)
    s_cbranch_vccnz L_p25
    s_waitcnt vmcnt(4)
L_p25:
    buffer_load_dwordx4 v4, s[20:23], s74 offen nt lds
    v_readlane_b32 s92, v252, 16
    v_readlane_b32 s93, v252, 17
    v_readlane_b32 s94, v252, 18
    v_readlane_b32 s95, v252, 19
    v_bfe_u32 v236, s92, v11, 5
    v_bfe_u32 v237, s93, v11, 5
    v_bfe_u32 v238, s94, v11, 5
    v_bfe_u32 v239, s95, v11, 5
    v_cmp_lt_u32 s[84:85], v12, v236
    v_cmp_lt_u32 s[86:87], v12, v237
    v_cmp_lt_u32 s[88:89], v12, v238
    v_cmp_lt_u32 s[90:91], v12, v239
    v_cndmask_b32 v192, v13, v192, s[84:85]
    v_cndmask_b32 v193, v13, v193, s[86:87]
    v_cndmask_b32 v194, v13, v194, s[88:89]
    v_cndmask_b32 v195, v13, v195, s[90:91]
    v_max3_f32 v15, v192, v193, v15
    v_max3_f32 v15, v194, v195, v15
    s_add_u32 m0, s41, 31744
    s_waitcnt vmcnt(8)
    s_cbranch_vccnz L_p26
    s_waitcnt vmcnt(4)
L_p26:
    buffer_load_dwordx4 v5, s[20:23], s75 offen nt lds
    s_add_u32 m0, s41, 32768
    s_waitcnt vmcnt(8)
    s_cbranch_vccnz L_p27
    s_waitcnt vmcnt(4)
L_p27:
    buffer_load_dwordx4 v2, s[20:23], s76 offen nt lds
    ds_read_b128 a[32:35], v6 offset:20480
    ds_read_b128 a[36:39], v7 offset:20480
    ds_read_b128 a[40:43], v8 offset:20480
    ds_read_b128 a[44:47], v9 offset:20480
    s_add_u32 m0, s41, 33792
    s_waitcnt vmcnt(8)
    s_cbranch_vccnz L_p28
    s_waitcnt vmcnt(4)
L_p28:
    buffer_load_dwordx4 v3, s[20:23], s77 offen nt lds
    s_waitcnt lgkmcnt(0)
    v_mfma_f32_16x16x32_bf16 v[196:199], a[32:35], a[0:3], 0
    v_mfma_f32_16x16x32_bf16 v[196:199], a[36:39], a[4:7], v[196:199]
    v_mfma_f32_16x16x32_bf16 v[196:199], a[40:43], a[8:11], v[196:199]
    v_mfma_f32_16x16x32_bf16 v[196:199], a[44:47], a[12:15], v[196:199]
    s_add_u32 m0, s41, 34816
    s_waitcnt vmcnt(8)
    s_cbranch_vccnz L_p29
    s_waitcnt vmcnt(4)
L_p29:
    buffer_load_dwordx4 v4, s[20:23], s78 offen nt lds
    v_readlane_b32 s92, v252, 20
    v_readlane_b32 s93, v252, 21
    v_readlane_b32 s94, v252, 22
    v_readlane_b32 s95, v252, 23
    v_bfe_u32 v236, s92, v11, 5
    v_bfe_u32 v237, s93, v11, 5
    v_bfe_u32 v238, s94, v11, 5
    v_bfe_u32 v239, s95, v11, 5
    v_cmp_lt_u32 s[84:85], v12, v236
    v_cmp_lt_u32 s[86:87], v12, v237
    v_cmp_lt_u32 s[88:89], v12, v238
    v_cmp_lt_u32 s[90:91], v12, v239
    v_cndmask_b32 v196, v13, v196, s[84:85]
    v_cndmask_b32 v197, v13, v197, s[86:87]
    v_cndmask_b32 v198, v13, v198, s[88:89]
    v_cndmask_b32 v199, v13, v199, s[90:91]
    v_max3_f32 v15, v196, v197, v15
    v_max3_f32 v15, v198, v199, v15
    s_add_u32 m0, s41, 35840
    s_waitcnt vmcnt(8)
    s_cbranch_vccnz L_p30
    s_waitcnt vmcnt(4)
L_p30:
    buffer_load_dwordx4 v5, s[20:23], s79 offen nt lds
    s_cmp_le_u32 s32, 36
    s_cbranch_scc1 L_skip
    s_add_u32 m0, s41, 36864
    s_waitcnt vmcnt(8)
    s_cbranch_vccnz L_p31
    s_waitcnt vmcnt(4)
L_p31:
    buffer_load_dwordx4 v2, s[20:23], s80 offen nt lds
    s_waitcnt vmcnt(8)
    s_cbranch_vccnz L_p32
    s_waitcnt vmcnt(4)
L_p32:
    buffer_load_dwordx4 v[160:163], v10, s[24:27], s80 offen nt
    s_cmp_le_u32 s32, 37
    s_cbranch_scc1 L_skip
    s_add_u32 m0, s41, 37888
    s_waitcnt vmcnt(8)
    s_cbranch_vccnz L_p33
    s_waitcnt vmcnt(4)
L_p33:
    buffer_load_dwordx4 v3, s[20:23], s81 offen nt lds
    s_waitcnt vmcnt(8)
    s_cbranch_vccnz L_p34
    s_waitcnt vmcnt(4)
L_p34:
    buffer_load_dwordx4 v[164:167], v10, s[24:27], s81 offen nt
    s_cmp_le_u32 s32, 38
    s_cbranch_scc1 L_skip
    s_add_u32 m0, s41, 38912
    s_waitcnt vmcnt(8)
    s_cbranch_vccnz L_p35
    s_waitcnt vmcnt(4)
L_p35:
    buffer_load_dwordx4 v4, s[20:23], s82 offen nt lds
    s_waitcnt vmcnt(8)
    s_cbranch_vccnz L_p36
    s_waitcnt vmcnt(4)
L_p36:
    buffer_load_dwordx4 v[168:171], v10, s[24:27], s82 offen nt
    s_cmp_le_u32 s32, 39
    s_cbranch_scc1 L_skip
    s_add_u32 m0, s41, 39936
    s_waitcnt vmcnt(8)
    s_cbranch_vccnz L_p37
    s_waitcnt vmcnt(4)
L_p37:
    buffer_load_dwordx4 v5, s[20:23], s83 offen nt lds
    s_waitcnt vmcnt(8)
    s_cbranch_vccnz L_p38
    s_waitcnt vmcnt(4)
L_p38:
    buffer_load_dwordx4 v[172:175], v10, s[24:27], s83 offen nt
L_skip:
    s_waitcnt vmcnt(8)
    s_cbranch_vccnz L_p39
    s_waitcnt vmcnt(4)
L_p39:
    buffer_load_dwordx4 v[16:19], v10, s[24:27], s44 offen nt
    ds_read_b128 a[16:19], v6 offset:24576
    ds_read_b128 a[20:23], v7 offset:24576
    ds_read_b128 a[24:27], v8 offset:24576
    ds_read_b128 a[28:31], v9 offset:24576
    s_waitcnt vmcnt(8)
    s_cbranch_vccnz L_p40
    s_waitcnt vmcnt(4)
L_p40:
    buffer_load_dwordx4 v[20:23], v10, s[24:27], s45 offen nt
    s_waitcnt lgkmcnt(0)
    v_mfma_f32_16x16x32_bf16 v[200:203], a[16:19], a[0:3], 0
    v_mfma_f32_16x16x32_bf16 v[200:203], a[20:23], a[4:7], v[200:203]
    v_mfma_f32_16x16x32_bf16 v[200:203], a[24:27], a[8:11], v[200:203]
    v_mfma_f32_16x16x32_bf16 v[200:203], a[28:31], a[12:15], v[200:203]
    s_waitcnt vmcnt(8)
    s_cbranch_vccnz L_p41
    s_waitcnt vmcnt(5)
L_p41:
    buffer_load_dwordx4 v[24:27], v10, s[24:27], s46 offen nt
    v_readlane_b32 s92, v252, 24
    v_readlane_b32 s93, v252, 25
    v_readlane_b32 s94, v252, 26
    v_readlane_b32 s95, v252, 27
    v_bfe_u32 v236, s92, v11, 5
    v_bfe_u32 v237, s93, v11, 5
    v_bfe_u32 v238, s94, v11, 5
    v_bfe_u32 v239, s95, v11, 5
    v_cmp_lt_u32 s[84:85], v12, v236
    v_cmp_lt_u32 s[86:87], v12, v237
    v_cmp_lt_u32 s[88:89], v12, v238
    v_cmp_lt_u32 s[90:91], v12, v239
    v_cndmask_b32 v200, v13, v200, s[84:85]
    v_cndmask_b32 v201, v13, v201, s[86:87]
    v_cndmask_b32 v202, v13, v202, s[88:89]
    v_cndmask_b32 v203, v13, v203, s[90:91]
    v_max3_f32 v15, v200, v201, v15
    v_max3_f32 v15, v202, v203, v15
    s_waitcnt vmcnt(8)
    s_cbranch_vccnz L_p42
    s_waitcnt vmcnt(5)
L_p42:
    buffer_load_dwordx4 v[28:31], v10, s[24:27], s47 offen nt
    s_waitcnt vmcnt(8)
    s_cbranch_vccnz L_p43
    s_waitcnt vmcnt(5)
L_p43:
    buffer_load_dwordx4 v[32:35], v10, s[24:27], s48 offen nt
    ds_read_b128 a[32:35], v6 offset:28672
    ds_read_b128 a[36:39], v7 offset:28672
    ds_read_b128 a[40:43], v8 offset:28672
    ds_read_b128 a[44:47], v9 offset:28672
    s_cmp_lg_u32 s3, s34
    s_cbranch_scc1 L_nocnt
    s_lshl_b32 s36, s30, 6
    v_and_b32 v255, 0, v1
    v_lshl_add_u32 v255, v255, 2, s36
    global_load_dword v255, v255, s[16:17] sc1
L_nocnt:
    s_waitcnt vmcnt(8)
    s_cbranch_vccnz L_p44
    s_waitcnt vmcnt(5)
L_p44:
    buffer_load_dwordx4 v[36:39], v10, s[24:27], s49 offen nt
    s_waitcnt lgkmcnt(0)
    v_mfma_f32_16x16x32_bf16 v[204:207], a[32:35], a[0:3], 0
    v_mfma_f32_16x16x32_bf16 v[204:207], a[36:39], a[4:7], v[204:207]
    v_mfma_f32_16x16x32_bf16 v[204:207], a[40:43], a[8:11], v[204:207]
    v_mfma_f32_16x16x32_bf16 v[204:207], a[44:47], a[12:15], v[204:207]
    s_waitcnt vmcnt(8)
    s_cbranch_vccnz L_p45
    s_waitcnt vmcnt(5)
L_p45:
    buffer_load_dwordx4 v[40:43], v10, s[24:27], s50 offen nt
    v_readlane_b32 s92, v252, 28
    v_readlane_b32 s93, v252, 29
    v_readlane_b32 s94, v252, 30
    v_readlane_b32 s95, v252, 31
    v_bfe_u32 v236, s92, v11, 5
    v_bfe_u32 v237, s93, v11, 5
    v_bfe_u32 v238, s94, v11, 5
    v_bfe_u32 v239, s95, v11, 5
    v_cmp_lt_u32 s[84:85], v12, v236
    v_cmp_lt_u32 s[86:87], v12, v237
    v_cmp_lt_u32 s[88:89], v12, v238
    v_cmp_lt_u32 s[90:91], v12, v239
    v_cndmask_b32 v204, v13, v204, s[84:85]
    v_cndmask_b32 v205, v13, v205, s[86:87]
    v_cndmask_b32 v206, v13, v206, s[88:89]
    v_cndmask_b32 v207, v13, v207, s[90:91]
    v_max3_f32 v15, v204, v205, v15
    v_max3_f32 v15, v206, v207, v15
    s_waitcnt vmcnt(8)
    s_cbranch_vccnz L_p46
    s_waitcnt vmcnt(5)
L_p46:
    buffer_load_dwordx4 v[44:47], v10, s[24:27], s51 offen nt
    s_waitcnt vmcnt(8)
    s_cbranch_vccnz L_p47
    s_waitcnt vmcnt(7)
L_p47:
    buffer_load_dwordx4 v[48:51], v10, s[24:27], s52 offen nt
    ds_read_b128 a[16:19], v6 offset:32768
    ds_read_b128 a[20:23], v7 offset:32768
    ds_read_b128 a[24:27], v8 offset:32768
    ds_read_b128 a[28:31], v9 offset:32768
    ds_read_b128 a[32:35], v6 offset:36864
    ds_read_b128 a[36:39], v7 offset:36864
    ds_read_b128 a[40:43], v8 offset:36864
    ds_read_b128 a[44:47], v9 offset:36864
    s_waitcnt vmcnt(8)
    s_cbranch_vccnz L_p48
    s_waitcnt vmcnt(7)
L_p48:
    buffer_load_dwordx4 v[52:55], v10, s[24:27], s53 offen nt
    s_waitcnt lgkmcnt(0)
    v_mfma_f32_16x16x32_bf16 v[208:211], a[16:19], a[0:3], 0
    v_mfma_f32_16x16x32_bf16 v[208:211], a[20:23], a[4:7], v[208:211]
    v_mfma_f32_16x16x32_bf16 v[208:211], a[24:27], a[8:11], v[208:211]
    v_mfma_f32_16x16x32_bf16 v[208:211], a[28:31], a[12:15], v[208:211]
    s_waitcnt lgkmcnt(0)
    v_mfma_f32_16x16x32_bf16 v[212:215], a[32:35], a[0:3], 0
    v_mfma_f32_16x16x32_bf16 v[212:215], a[36:39], a[4:7], v[212:215]
    v_mfma_f32_16x16x32_bf16 v[212:215], a[40:43], a[8:11], v[212:215]
    v_mfma_f32_16x16x32_bf16 v[212:215], a[44:47], a[12:15], v[212:215]
    s_waitcnt vmcnt(8)
    s_cbranch_vccnz L_p49
    s_waitcnt vmcnt(7)
L_p49:
    buffer_load_dwordx4 v[56:59], v10, s[24:27], s54 offen nt
    v_readlane_b32 s92, v252, 32
    v_readlane_b32 s93, v252, 33
    v_readlane_b32 s94, v252, 34
    v_readlane_b32 s95, v252, 35
    v_bfe_u32 v236, s92, v11, 5
    v_bfe_u32 v237, s93, v11, 5
    v_bfe_u32 v238, s94, v11, 5
    v_bfe_u32 v239, s95, v11, 5
    v_cmp_lt_u32 s[84:85], v12, v236
    v_cmp_lt_u32 s[86:87], v12, v237
    v_cmp_lt_u32 s[88:89], v12, v238
    v_cmp_lt_u32 s[90:91], v12, v239
    v_cndmask_b32 v208, v13, v208, s[84:85]
    v_cndmask_b32 v209, v13, v209, s[86:87]
    v_cndmask_b32 v210, v13, v210, s[88:89]
    v_cndmask_b32 v211, v13, v211, s[90:91]
    v_max3_f32 v15, v208, v209, v15
    v_max3_f32 v15, v210, v211, v15
    v_readlane_b32 s92, v252, 36
    v_readlane_b32 s93, v252, 37
    v_readlane_b32 s94, v252, 38
    v_readlane_b32 s95, v252, 39
    v_bfe_u32 v236, s92, v11, 5
    v_bfe_u32 v237, s93, v11, 5
    v_bfe_u32 v238, s94, v11, 5
    v_bfe_u32 v239, s95, v11, 5
    v_cmp_lt_u32 s[84:85], v12, v236
    v_cmp_lt_u32 s[86:87], v12, v237
    v_cmp_lt_u32 s[88:89], v12, v238
    v_cmp_lt_u32 s[90:91], v12, v239
    v_cndmask_b32 v212, v13, v212, s[84:85]
    v_cndmask_b32 v213, v13, v213, s[86:87]
    v_cndmask_b32 v214, v13, v214, s[88:89]
    v_cndmask_b32 v215, v13, v215, s[90:91]
    v_max3_f32 v15, v212, v213, v15
    v_max3_f32 v15, v214, v215, v15
    v_and_b32 v236, 15, v1
    v_lshlrev_b32 v236, 4, v236
    v_and_b32 v237, 12, v12
    v_add3_u32 v237, v236, v237, s41
    ds_write_b32 v237, v15
    v_add_u32 v238, 81920, v236
    s_waitcnt vmcnt(8)
    s_cbranch_vccnz L_p50
    s_waitcnt vmcnt(7)
L_p50:
    buffer_load_dwordx4 v[60:63], v10, s[24:27], s55 offen nt
    s_waitcnt lgkmcnt(0)
    s_barrier
    ds_read_b128 v[216:219], v236
    ds_read_b128 v[220:223], v236 offset:40960
    ds_read_b128 v[224:227], v238
    ds_read_b128 v[228:231], v238 offset:40960
    s_waitcnt vmcnt(8)
    s_cbranch_vccnz L_p51
    s_waitcnt vmcnt(7)
L_p51:
    buffer_load_dwordx4 v[64:67], v10, s[24:27], s56 offen nt
    s_waitcnt lgkmcnt(0)
    v_max3_f32 v253, v216, v217, v218
    v_max3_f32 v253, v219, v220, v253
    v_max3_f32 v253, v221, v222, v253
    v_max3_f32 v253, v223, v224, v253
    v_max3_f32 v253, v225, v226, v253
    v_max3_f32 v253, v227, v228, v253
    v_max3_f32 v253, v229, v230, v253
    v_max_f32 v253, v231, v253
    s_cmp_lg_u32 s33, 0
    s_cbranch_scc1 L_resc
L_noresc:
    v_mov_b32 v14, v253
    v_mul_f32 v15, s40, v253
    v_fma_f32 v212, v212, s40, -v15
    v_fma_f32 v213, v213, s40, -v15
    v_fma_f32 v214, v214, s40, -v15
    v_fma_f32 v215, v215, s40, -v15
    v_fma_f32 v176, v176, s40, -v15
    v_fma_f32 v177, v177, s40, -v15
    v_fma_f32 v178, v178, s40, -v15
    v_fma_f32 v179, v179, s40, -v15
    v_exp_f32 v212, v212
    v_exp_f32 v213, v213
    v_exp_f32 v214, v214
    v_exp_f32 v215, v215
    v_exp_f32 v176, v176
    v_exp_f32 v177, v177
    v_exp_f32 v178, v178
    v_exp_f32 v179, v179
    v_cvt_pk_bf16_f32 v216, v212, v213
    v_cvt_pk_bf16_f32 v217, v214, v215
    v_cvt_pk_bf16_f32 v218, v176, v177
    v_cvt_pk_bf16_f32 v219, v178, v179
    s_waitcnt vmcnt(8)
    s_cbranch_vccnz L_p52
    s_waitcnt vmcnt(7)
L_p52:
    buffer_load_dwordx4 v[68:71], v10, s[24:27], s57 offen nt
    v_fma_f32 v180, v180, s40, -v15
    v_fma_f32 v181, v181, s40, -v15
    v_fma_f32 v182, v182, s40, -v15
    v_fma_f32 v183, v183, s40, -v15
    v_fma_f32 v184, v184, s40, -v15
    v_fma_f32 v185, v185, s40, -v15
    v_fma_f32 v186, v186, s40, -v15
    v_fma_f32 v187, v187, s40, -v15
    v_exp_f32 v180, v180
    v_exp_f32 v181, v181
    v_exp_f32 v182, v182
    v_exp_f32 v183, v183
    v_exp_f32 v184, v184
    v_exp_f32 v185, v185
    v_exp_f32 v186, v186
    v_exp_f32 v187, v187
    v_cvt_pk_bf16_f32 v220, v180, v181
    v_cvt_pk_bf16_f32 v221, v182, v183
    v_cvt_pk_bf16_f32 v222, v184, v185
    v_cvt_pk_bf16_f32 v223, v186, v187
    s_waitcnt vmcnt(8)
    s_cbranch_vccnz L_p53
    s_waitcnt vmcnt(7)
L_p53:
    buffer_load_dwordx4 v[72:75], v10, s[24:27], s58 offen nt
    v_fma_f32 v188, v188, s40, -v15
    v_fma_f32 v189, v189, s40, -v15
    v_fma_f32 v190, v190, s40, -v15
    v_fma_f32 v191, v191, s40, -v15
    v_fma_f32 v192, v192, s40, -v15
    v_fma_f32 v193, v193, s40, -v15
    v_fma_f32 v194, v194, s40, -v15
    v_fma_f32 v195, v195, s40, -v15
    v_exp_f32 v188, v188
    v_exp_f32 v189, v189
    v_exp_f32 v190, v190
    v_exp_f32 v191, v191
    v_exp_f32 v192, v192
    v_exp_f32 v193, v193
    v_exp_f32 v194, v194
    v_exp_f32 v195, v195
    v_cvt_pk_bf16_f32 v224, v188, v189
    v_cvt_pk_bf16_f32 v225, v190, v191
    v_cvt_pk_bf16_f32 v226, v192, v193
    v_cvt_pk_bf16_f32 v227, v194, v195
    s_waitcnt vmcnt(8)
    s_cbranch_vccnz L_p54
    s_waitcnt vmcnt(7)
L_p54:
    buffer_load_dwordx4 v[76:79], v10, s[24:27], s59 offen nt
    v_fma_f32 v196, v196, s40, -v15
    v_fma_f32 v197, v197, s40, -v15
    v_fma_f32 v198, v198, s40, -v15
    v_fma_f32 v199, v199, s40, -v15
    v_fma_f32 v200, v200, s40, -v15
    v_fma_f32 v201, v201, s40, -v15
    v_fma_f32 v202, v202, s40, -v15
    v_fma_f32 v203, v203, s40, -v15
    v_exp_f32 v196, v196
    v_exp_f32 v197, v197
    v_exp_f32 v198, v198
    v_exp_f32 v199, v199
    v_exp_f32 v200, v200
    v_exp_f32 v201, v201
    v_exp_f32 v202, v202
    v_exp_f32 v203, v203
    v_cvt_pk_bf16_f32 v228, v196, v197
    v_cvt_pk_bf16_f32 v229, v198, v199
    v_cvt_pk_bf16_f32 v230, v200, v201
    v_cvt_pk_bf16_f32 v231, v202, v203
    s_waitcnt vmcnt(8)
    s_cbranch_vccnz L_p55
    s_waitcnt vmcnt(7)
L_p55:
    buffer_load_dwordx4 v[80:83], v10, s[24:27], s60 offen nt
    v_fma_f32 v204, v204, s40, -v15
    v_fma_f32 v205, v205, s40, -v15
    v_fma_f32 v206, v206, s40, -v15
    v_fma_f32 v207, v207, s40, -v15
    v_fma_f32 v208, v208, s40, -v15
    v_fma_f32 v209, v209, s40, -v15
    v_fma_f32 v210, v210, s40, -v15
    v_fma_f32 v211, v211, s40, -v15
    v_exp_f32 v204, v204
    v_exp_f32 v205, v205
    v_exp_f32 v206, v206
    v_exp_f32 v207, v207
    v_exp_f32 v208, v208
    v_exp_f32 v209, v209
    v_exp_f32 v210, v210
    v_exp_f32 v211, v211
    v_cvt_pk_bf16_f32 v232, v204, v205
    v_cvt_pk_bf16_f32 v233, v206, v207
    v_cvt_pk_bf16_f32 v234, v208, v209
    v_cvt_pk_bf16_f32 v235, v210, v211
    s_waitcnt vmcnt(8)
    s_cbranch_vccnz L_p56
    s_waitcnt vmcnt(7)
L_p56:
    buffer_load_dwordx4 v[84:87], v10, s[24:27], s61 offen nt
    v_and_b32 v0, 15, v1
    v_accvgpr_read_b32 v194, a88
    v_accvgpr_read_b32 v195, a89
    v_mfma_f32_16x16x32_bf16 a[80:83], a[84:87], v[216:219], a[80:83]
    v_mfma_f32_16x16x32_bf16 a[80:83], a[84:87], v[220:223], a[80:83]
    v_mfma_f32_16x16x32_bf16 a[80:83], a[84:87], v[224:227], a[80:83]
    v_mfma_f32_16x16x32_bf16 a[80:83], a[84:87], v[228:231], a[80:83]
    v_mfma_f32_16x16x32_bf16 a[80:83], a[84:87], v[232:235], a[80:83]
    v_cmp_ne_u32 s[84:85], 0, v194
    v_cmp_ne_u32 s[86:87], 0, v195
    v_lshlrev_b32 v241, 2, v0
    v_lshlrev_b32 v0, 4, v0
    v_lshrrev_b64 v[242:243], v241, s[84:85]
    v_lshrrev_b64 v[244:245], v241, s[86:87]
    v_lshl_add_u32 v237, s3, 2, v0
    v_and_b32 v242, 15, v242
    v_lshl_or_b32 v242, v244, 4, v242
    v_add_u32 v241, s3, v241
    ds_write_b32 v237, a80 offset:2048
    ds_write_b8 v241, v242 offset:2304
    s_waitcnt vmcnt(8)
    s_cbranch_vccnz L_p57
    s_waitcnt vmcnt(7)
L_p57:
    buffer_load_dwordx4 v[88:91], v10, s[24:27], s62 offen nt
    v_bfe_u32 v238, v1, 1, 2
    v_and_b32 v239, 1, v1
    v_lshl_add_u32 v238, v239, 2, v238
    s_lshl_b32 s36, s3, 13
    v_lshl_add_u32 v239, v1, 7, s36
    v_xor_b32 v240, 0, v238
    v_lshl_add_u32 v176, v240, 4, v239
    v_xor_b32 v240, 1, v238
    v_lshl_add_u32 v177, v240, 4, v239
    v_xor_b32 v240, 2, v238
    v_lshl_add_u32 v178, v240, 4, v239
    v_xor_b32 v240, 3, v238
    v_lshl_add_u32 v179, v240, 4, v239
    v_xor_b32 v240, 4, v238
    v_lshl_add_u32 v180, v240, 4, v239
    v_xor_b32 v240, 5, v238
    v_lshl_add_u32 v181, v240, 4, v239
    v_xor_b32 v240, 6, v238
    v_lshl_add_u32 v182, v240, 4, v239
    v_xor_b32 v240, 7, v238
    v_lshl_add_u32 v183, v240, 4, v239
    s_waitcnt vmcnt(8)
    s_cbranch_vccnz L_p58
    s_waitcnt vmcnt(7)
L_p58:
    buffer_load_dwordx4 v[92:95], v10, s[24:27], s63 offen nt
    s_cmp_lg_u32 s3, s34
    s_cbranch_scc1 L_cntok
    v_cmp_eq_u32 s[84:85], 0, v255
    s_cmp_lg_u64 s[84:85], 0
    s_cbranch_scc1 L_cntspin
L_cntok:
    v_lshrrev_b32 v239, 2, v1
    v_lshlrev_b32 v241, 4, v239
    v_lshrrev_b32 v242, 2, v0
    s_waitcnt lgkmcnt(0)
    s_barrier
    ds_read_b128 v[244:247], v0 offset:2048
    ds_read_b128 v[248:251], v241 offset:2048
    ds_read_b32 v189, v242 offset:2304
    v_and_b32 v238, 3, v1
    v_bfe_u32 v240, v1, 3, 2
    v_and_b32 v241, 4, v1
    v_or_b32 v240, v240, v241
    v_lshlrev_b32 v241, 1, v238
    v_xor_b32 v240, v240, v241
    s_lshl_b32 s36, s3, 11
    v_lshl_add_u32 v240, v240, 4, s36
    v_lshl_add_u32 v184, v239, 7, v240
    v_xor_b32 v191, 16, v184
    s_lshr_b32 s36, s31, 1
    s_xor_b32 s36, s36, s31
    s_and_b32 s36, s36, 1
    s_mul_i32 s36, s36, 3
    s_xor_b32 s35, s31, s36
    s_lshl_b32 s36, s30, 18
    s_and_b32 s37, s35, 7
    s_lshl_b32 s37, s37, 6
    s_add_u32 s36, s36, s37
    s_lshr_b32 s37, s35, 3
    s_lshl_b32 s37, s37, 15
    s_add_u32 s36, s36, s37
    v_lshl_add_u32 v240, v239, 11, s36
    v_lshl_add_u32 v185, v238, 4, v240
    s_waitcnt vmcnt(8)
    s_cbranch_vccnz L_p59
    s_waitcnt vmcnt(7)
L_p59:
    buffer_load_dwordx4 v[96:99], v10, s[24:27], s64 offen nt
    s_lshl_b32 s36, s30, 13
    s_add_u32 s36, s36, 1048576
    s_lshl_b32 s37, s31, 7
    s_add_u32 s37, s37, s36
    v_lshl_add_u32 v190, v1, 3, s37
    s_and_b32 s37, s35, 15
    s_lshl3_add_u32 s36, s37, s36
    v_lshl_add_u32 v186, v1, 7, s36
    s_lshr_b32 s36, s37, 3
    s_lshl_b32 s36, s36, 13
    s_and_b32 s37, s37, 7
    s_lshl_b32 s37, s37, 8
    s_add_u32 s36, s36, s37
    s_lshl_b32 s37, s30, 11
    s_add_u32 s36, s36, s37
    s_lshr_b32 s37, s35, 4
    v_lshl_add_u32 v196, s37, 3, v238
    s_lshl_b32 s37, s37, 6
    s_add_u32 s36, s36, s37
    v_and_b32 v240, 48, v1
    v_lshl_add_u32 v240, v238, 2, v240
    v_add_u32 v187, s36, v240
    s_waitcnt lgkmcnt(0)
    v_add_f32 v244, v244, v245
    v_add_f32 v248, v248, v249
    v_add_f32 v246, v246, v247
    v_add_f32 v250, v250, v251
    v_add_f32 v244, v244, v246
    v_add_f32 v248, v248, v250
    v_log_f32 v244, v244
    v_max_f32 v248, 0xda24260, v248
    v_rcp_f32 v192, v248
    v_add_f32 v244, v244, v15
    v_min_u32 v188, -2, v244
    s_waitcnt vmcnt(8)
    s_cbranch_vccnz L_p60
    s_waitcnt vmcnt(7)
L_p60:
    buffer_load_dwordx4 v[100:103], v10, s[24:27], s65 offen nt
    v_perm_b32 v236, v164, v160, s38
    v_perm_b32 v237, v172, v168, s38
    v_perm_b32 v238, v20, v16, s38
    v_perm_b32 v239, v28, v24, s38
    v_perm_b32 v240, v164, v160, s39
    v_perm_b32 v241, v172, v168, s39
    v_perm_b32 v242, v20, v16, s39
    v_perm_b32 v243, v28, v24, s39
    v_perm_b32 v244, v165, v161, s38
    v_perm_b32 v245, v173, v169, s38
    v_perm_b32 v246, v21, v17, s38
    v_perm_b32 v247, v29, v25, s38
    v_perm_b32 v248, v165, v161, s39
    v_perm_b32 v249, v173, v169, s39
    v_perm_b32 v250, v21, v17, s39
    v_perm_b32 v251, v29, v25, s39
    v_mfma_f32_16x16x32_bf16 a[48:51], v[236:239], v[216:219], a[48:51]
    v_mfma_f32_16x16x32_bf16 a[52:55], v[240:243], v[216:219], a[52:55]
    v_mfma_f32_16x16x32_bf16 a[56:59], v[244:247], v[216:219], a[56:59]
    v_mfma_f32_16x16x32_bf16 a[60:63], v[248:251], v[216:219], a[60:63]
    s_waitcnt vmcnt(8)
    s_cbranch_vccnz L_p61
    s_waitcnt vmcnt(7)
L_p61:
    buffer_load_dwordx4 v[104:107], v10, s[24:27], s66 offen nt
    v_perm_b32 v236, v166, v162, s38
    v_perm_b32 v237, v174, v170, s38
    v_perm_b32 v238, v22, v18, s38
    v_perm_b32 v239, v30, v26, s38
    v_perm_b32 v240, v166, v162, s39
    v_perm_b32 v241, v174, v170, s39
    v_perm_b32 v242, v22, v18, s39
    v_perm_b32 v243, v30, v26, s39
    v_perm_b32 v244, v167, v163, s38
    v_perm_b32 v245, v175, v171, s38
    v_perm_b32 v246, v23, v19, s38
    v_perm_b32 v247, v31, v27, s38
    v_perm_b32 v248, v167, v163, s39
    v_perm_b32 v249, v175, v171, s39
    v_perm_b32 v250, v23, v19, s39
    v_perm_b32 v251, v31, v27, s39
    v_mfma_f32_16x16x32_bf16 a[64:67], v[236:239], v[216:219], a[64:67]
    v_mfma_f32_16x16x32_bf16 a[68:71], v[240:243], v[216:219], a[68:71]
    v_mfma_f32_16x16x32_bf16 a[72:75], v[244:247], v[216:219], a[72:75]
    v_mfma_f32_16x16x32_bf16 a[76:79], v[248:251], v[216:219], a[76:79]
    s_waitcnt vmcnt(8)
    s_cbranch_vccnz L_p62
    s_waitcnt vmcnt(7)
L_p62:
    buffer_load_dwordx4 v[108:111], v10, s[24:27], s67 offen nt
    v_perm_b32 v236, v36, v32, s38
    v_perm_b32 v237, v44, v40, s38
    v_perm_b32 v238, v52, v48, s38
    v_perm_b32 v239, v60, v56, s38
    v_perm_b32 v240, v36, v32, s39
    v_perm_b32 v241, v44, v40, s39
    v_perm_b32 v242, v52, v48, s39
    v_perm_b32 v243, v60, v56, s39
    v_perm_b32 v244, v37, v33, s38
    v_perm_b32 v245, v45, v41, s38
    v_perm_b32 v246, v53, v49, s38
    v_perm_b32 v247, v61, v57, s38
    v_perm_b32 v248, v37, v33, s39
    v_perm_b32 v249, v45, v41, s39
    v_perm_b32 v250, v53, v49, s39
    v_perm_b32 v251, v61, v57, s39
    v_mfma_f32_16x16x32_bf16 a[48:51], v[236:239], v[220:223], a[48:51]
    v_mfma_f32_16x16x32_bf16 a[52:55], v[240:243], v[220:223], a[52:55]
    v_mfma_f32_16x16x32_bf16 a[56:59], v[244:247], v[220:223], a[56:59]
    v_mfma_f32_16x16x32_bf16 a[60:63], v[248:251], v[220:223], a[60:63]
    s_waitcnt vmcnt(8)
    s_cbranch_vccnz L_p63
    s_waitcnt vmcnt(7)
L_p63:
    buffer_load_dwordx4 v[112:115], v10, s[24:27], s68 offen nt
    v_perm_b32 v236, v38, v34, s38
    v_perm_b32 v237, v46, v42, s38
    v_perm_b32 v238, v54, v50, s38
    v_perm_b32 v239, v62, v58, s38
    v_perm_b32 v240, v38, v34, s39
    v_perm_b32 v241, v46, v42, s39
    v_perm_b32 v242, v54, v50, s39
    v_perm_b32 v243, v62, v58, s39
    v_perm_b32 v244, v39, v35, s38
    v_perm_b32 v245, v47, v43, s38
    v_perm_b32 v246, v55, v51, s38
    v_perm_b32 v247, v63, v59, s38
    v_perm_b32 v248, v39, v35, s39
    v_perm_b32 v249, v47, v43, s39
    v_perm_b32 v250, v55, v51, s39
    v_perm_b32 v251, v63, v59, s39
    v_mfma_f32_16x16x32_bf16 a[64:67], v[236:239], v[220:223], a[64:67]
    v_mfma_f32_16x16x32_bf16 a[68:71], v[240:243], v[220:223], a[68:71]
    v_mfma_f32_16x16x32_bf16 a[72:75], v[244:247], v[220:223], a[72:75]
    v_mfma_f32_16x16x32_bf16 a[76:79], v[248:251], v[220:223], a[76:79]
    s_waitcnt vmcnt(8)
    s_cbranch_vccnz L_p64
    s_waitcnt vmcnt(7)
L_p64:
    buffer_load_dwordx4 v[116:119], v10, s[24:27], s69 offen nt
    s_waitcnt vmcnt(8)
    s_cbranch_vccnz L_p65
    s_waitcnt vmcnt(7)
L_p65:
    buffer_load_dwordx4 v[120:123], v10, s[24:27], s70 offen nt
    s_waitcnt vmcnt(7)
    v_perm_b32 v236, v68, v64, s38
    v_perm_b32 v237, v76, v72, s38
    v_perm_b32 v238, v84, v80, s38
    v_perm_b32 v239, v92, v88, s38
    v_perm_b32 v240, v68, v64, s39
    v_perm_b32 v241, v76, v72, s39
    v_perm_b32 v242, v84, v80, s39
    v_perm_b32 v243, v92, v88, s39
    v_perm_b32 v244, v69, v65, s38
    v_perm_b32 v245, v77, v73, s38
    v_perm_b32 v246, v85, v81, s38
    v_perm_b32 v247, v93, v89, s38
    v_perm_b32 v248, v69, v65, s39
    v_perm_b32 v249, v77, v73, s39
    v_perm_b32 v250, v85, v81, s39
    v_perm_b32 v251, v93, v89, s39
    v_mfma_f32_16x16x32_bf16 a[48:51], v[236:239], v[224:227], a[48:51]
    v_mfma_f32_16x16x32_bf16 a[52:55], v[240:243], v[224:227], a[52:55]
    v_mfma_f32_16x16x32_bf16 a[56:59], v[244:247], v[224:227], a[56:59]
    v_mfma_f32_16x16x32_bf16 a[60:63], v[248:251], v[224:227], a[60:63]
    s_waitcnt vmcnt(8)
    s_cbranch_vccnz L_p66
    s_waitcnt vmcnt(7)
L_p66:
    buffer_load_dwordx4 v[124:127], v10, s[24:27], s71 offen nt
    v_perm_b32 v236, v70, v66, s38
    v_perm_b32 v237, v78, v74, s38
    v_perm_b32 v238, v86, v82, s38
    v_perm_b32 v239, v94, v90, s38
    v_perm_b32 v240, v70, v66, s39
    v_perm_b32 v241, v78, v74, s39
    v_perm_b32 v242, v86, v82, s39
    v_perm_b32 v243, v94, v90, s39
    v_perm_b32 v244, v71, v67, s38
    v_perm_b32 v245, v79, v75, s38
    v_perm_b32 v246, v87, v83, s38
    v_perm_b32 v247, v95, v91, s38
    v_perm_b32 v248, v71, v67, s39
    v_perm_b32 v249, v79, v75, s39
    v_perm_b32 v250, v87, v83, s39
    v_perm_b32 v251, v95, v91, s39
    v_mfma_f32_16x16x32_bf16 a[64:67], v[236:239], v[224:227], a[64:67]
    v_mfma_f32_16x16x32_bf16 a[68:71], v[240:243], v[224:227], a[68:71]
    v_mfma_f32_16x16x32_bf16 a[72:75], v[244:247], v[224:227], a[72:75]
    v_mfma_f32_16x16x32_bf16 a[76:79], v[248:251], v[224:227], a[76:79]
    s_waitcnt vmcnt(7)
    buffer_load_dwordx4 v[128:131], v10, s[24:27], s72 offen nt
    buffer_load_dwordx4 v[132:135], v10, s[24:27], s73 offen nt
    buffer_load_dwordx4 v[136:139], v10, s[24:27], s74 offen nt
    buffer_load_dwordx4 v[140:143], v10, s[24:27], s75 offen nt
    buffer_load_dwordx4 v[144:147], v10, s[24:27], s76 offen nt
    buffer_load_dwordx4 v[148:151], v10, s[24:27], s77 offen nt
    buffer_load_dwordx4 v[152:155], v10, s[24:27], s78 offen nt
    buffer_load_dwordx4 v[156:159], v10, s[24:27], s79 offen nt
    s_waitcnt vmcnt(8)
    v_perm_b32 v236, v100, v96, s38
    v_perm_b32 v237, v108, v104, s38
    v_perm_b32 v238, v116, v112, s38
    v_perm_b32 v239, v124, v120, s38
    v_perm_b32 v240, v100, v96, s39
    v_perm_b32 v241, v108, v104, s39
    v_perm_b32 v242, v116, v112, s39
    v_perm_b32 v243, v124, v120, s39
    v_perm_b32 v244, v101, v97, s38
    v_perm_b32 v245, v109, v105, s38
    v_perm_b32 v246, v117, v113, s38
    v_perm_b32 v247, v125, v121, s38
    v_perm_b32 v248, v101, v97, s39
    v_perm_b32 v249, v109, v105, s39
    v_perm_b32 v250, v117, v113, s39
    v_perm_b32 v251, v125, v121, s39
    v_mfma_f32_16x16x32_bf16 a[48:51], v[236:239], v[228:231], a[48:51]
    v_mfma_f32_16x16x32_bf16 a[52:55], v[240:243], v[228:231], a[52:55]
    v_mfma_f32_16x16x32_bf16 a[56:59], v[244:247], v[228:231], a[56:59]
    v_mfma_f32_16x16x32_bf16 a[60:63], v[248:251], v[228:231], a[60:63]
    v_perm_b32 v236, v102, v98, s38
    v_perm_b32 v237, v110, v106, s38
    v_perm_b32 v238, v118, v114, s38
    v_perm_b32 v239, v126, v122, s38
    v_perm_b32 v240, v102, v98, s39
    v_perm_b32 v241, v110, v106, s39
    v_perm_b32 v242, v118, v114, s39
    v_perm_b32 v243, v126, v122, s39
    v_perm_b32 v244, v103, v99, s38
    v_perm_b32 v245, v111, v107, s38
    v_perm_b32 v246, v119, v115, s38
    v_perm_b32 v247, v127, v123, s38
    v_perm_b32 v248, v103, v99, s39
    v_perm_b32 v249, v111, v107, s39
    v_perm_b32 v250, v119, v115, s39
    v_perm_b32 v251, v127, v123, s39
    v_mfma_f32_16x16x32_bf16 a[64:67], v[236:239], v[228:231], a[64:67]
    v_mfma_f32_16x16x32_bf16 a[68:71], v[240:243], v[228:231], a[68:71]
    v_mfma_f32_16x16x32_bf16 a[72:75], v[244:247], v[228:231], a[72:75]
    v_mfma_f32_16x16x32_bf16 a[76:79], v[248:251], v[228:231], a[76:79]
    s_mov_b32 s44, 0
    s_mov_b32 s45, 512
    s_mov_b32 s46, 1024
    s_mov_b32 s47, 1536
    s_mov_b64 vcc, 0
    s_waitcnt vmcnt(6)
    v_perm_b32 v32, v132, v128, s38
    v_perm_b32 v36, v132, v128, s39
    v_perm_b32 v40, v133, v129, s38
    v_perm_b32 v44, v133, v129, s39
    v_perm_b32 v48, v134, v130, s38
    v_perm_b32 v52, v134, v130, s39
    v_perm_b32 v56, v135, v131, s38
    v_perm_b32 v60, v135, v131, s39
    s_waitcnt vmcnt(4)
    v_perm_b32 v33, v140, v136, s38
    v_perm_b32 v37, v140, v136, s39
    v_perm_b32 v41, v141, v137, s38
    v_perm_b32 v45, v141, v137, s39
    v_perm_b32 v49, v142, v138, s38
    v_perm_b32 v53, v142, v138, s39
    v_perm_b32 v57, v143, v139, s38
    v_perm_b32 v61, v143, v139, s39
    s_cmp_lg_u32 s3, s34
    s_cbranch_scc1 L_nodone
    s_mov_b64 exec, 0xffff
    global_store_dwordx2 v190, v[188:189], s[18:19] sc1
    s_mov_b64 exec, -1
    s_mov_b64 vcc, -1
L_nodone:
    s_waitcnt vmcnt(3)
    s_cbranch_vccnz L_p67
    s_waitcnt vmcnt(2)
L_p67:
    v_perm_b32 v34, v148, v144, s38
    v_perm_b32 v38, v148, v144, s39
    v_perm_b32 v42, v149, v145, s38
    v_perm_b32 v46, v149, v145, s39
    v_perm_b32 v50, v150, v146, s38
    v_perm_b32 v54, v150, v146, s39
    v_perm_b32 v58, v151, v147, s38
    v_perm_b32 v62, v151, v147, s39
    s_waitcnt vmcnt(1)
    s_cbranch_vccnz L_p68
    s_waitcnt vmcnt(0)
L_p68:
    v_perm_b32 v35, v156, v152, s38
    v_perm_b32 v39, v156, v152, s39
    v_perm_b32 v43, v157, v153, s38
    v_mfma_f32_16x16x32_bf16 a[48:51], v[32:35], v[232:235], a[48:51]
    v_perm_b32 v47, v157, v153, s39
    v_mfma_f32_16x16x32_bf16 a[52:55], v[36:39], v[232:235], a[52:55]
    v_perm_b32 v51, v158, v154, s38
    v_mfma_f32_16x16x32_bf16 a[56:59], v[40:43], v[232:235], a[56:59]
    v_perm_b32 v55, v158, v154, s39
    v_mfma_f32_16x16x32_bf16 a[60:63], v[44:47], v[232:235], a[60:63]
    v_perm_b32 v59, v159, v155, s38
    v_mfma_f32_16x16x32_bf16 a[64:67], v[48:51], v[232:235], a[64:67]
    v_perm_b32 v63, v159, v155, s39
    ds_write_b128 v176, a[48:51] offset:4096
    v_mfma_f32_16x16x32_bf16 a[68:71], v[52:55], v[232:235], a[68:71]
    ds_write_b128 v177, a[52:55] offset:4096
    v_mfma_f32_16x16x32_bf16 a[72:75], v[56:59], v[232:235], a[72:75]
    ds_write_b128 v178, a[56:59] offset:4096
    v_mfma_f32_16x16x32_bf16 a[76:79], v[60:63], v[232:235], a[76:79]
    ds_write_b128 v179, a[60:63] offset:4096
    s_cmp_gt_u32 s32, 40
    ds_write_b128 v180, a[64:67] offset:4096
    s_cbranch_scc1 L_more
    ds_write_b128 v181, a[68:71] offset:4096
    s_mov_b32 s20, s18
    ds_write_b128 v182, a[72:75] offset:4096
    s_mov_b32 s21, s19
    ds_write_b128 v183, a[76:79] offset:4096
    s_mov_b32 s22, 1048576
    s_mov_b32 s23, 0x20000
    s_waitcnt lgkmcnt(0)
    s_barrier
    ds_read_b128 v[32:35], v184 offset:4096
    ds_read_b128 v[36:39], v191 offset:4096
    ds_read_b128 v[40:43], v184 offset:12288
    ds_read_b128 v[44:47], v191 offset:12288
    ds_read_b128 v[48:51], v184 offset:20480
    ds_read_b128 v[52:55], v191 offset:20480
    ds_read_b128 v[56:59], v184 offset:28672
    ds_read_b128 v[60:63], v191 offset:28672
    s_waitcnt lgkmcnt(4)
    v_pk_add_f32 v[32:33], v[32:33], v[40:41]
    v_pk_add_f32 v[34:35], v[34:35], v[42:43]
    v_pk_add_f32 v[36:37], v[36:37], v[44:45]
    v_pk_add_f32 v[38:39], v[38:39], v[46:47]
    s_waitcnt lgkmcnt(2)
    v_pk_add_f32 v[32:33], v[32:33], v[48:49]
    v_pk_add_f32 v[34:35], v[34:35], v[50:51]
    v_pk_add_f32 v[36:37], v[36:37], v[52:53]
    v_pk_add_f32 v[38:39], v[38:39], v[54:55]
    v_pk_mul_f32 v[32:33], v[32:33], v[192:193] op_sel_hi:[1,0]
    v_pk_mul_f32 v[34:35], v[34:35], v[192:193] op_sel_hi:[1,0]
    v_pk_mul_f32 v[36:37], v[36:37], v[192:193] op_sel_hi:[1,0]
    v_pk_mul_f32 v[38:39], v[38:39], v[192:193] op_sel_hi:[1,0]
    s_waitcnt lgkmcnt(0)
    v_pk_fma_f32 v[32:33], v[56:57], v[192:193], v[32:33] op_sel_hi:[1,0,1]
    v_pk_fma_f32 v[36:37], v[60:61], v[192:193], v[36:37] op_sel_hi:[1,0,1]
    v_pk_fma_f32 v[34:35], v[58:59], v[192:193], v[34:35] op_sel_hi:[1,0,1]
    v_pk_fma_f32 v[38:39], v[62:63], v[192:193], v[38:39] op_sel_hi:[1,0,1]
    v_cvt_pk_bf16_f32 v40, v32, v36
    v_cvt_pk_bf16_f32 v42, v34, v38
    v_cvt_pk_bf16_f32 v41, v33, v37
    v_cvt_pk_bf16_f32 v43, v35, v39
    v_and_or_b32 v40, v40, -2, v194
    v_and_or_b32 v42, v42, -2, v195
    global_store_dwordx4 v254, v[40:43], s[18:19] sc1
    s_cmp_lg_u32 s3, 3
    s_cbranch_scc1 L_end
L_poll:
    global_load_dwordx2 v[16:17], v186, s[18:19] sc1
    s_sub_u32 s96, s96, 1
    s_cbranch_scc1 L_end
    s_waitcnt vmcnt(0)
    v_cmp_eq_u32 vcc, -1, v16
    s_and_b64 exec, exec, vcc
    s_cbranch_scc1 L_poll
    s_mov_b64 exec, -1
    buffer_load_dwordx4 v[88:91], v185, s[20:23], s44 offen sc1
    buffer_load_dwordx4 v[92:95], v185, s[20:23], s45 offen sc1
    buffer_load_dwordx4 v[96:99], v185, s[20:23], s46 offen sc1
    buffer_load_dwordx4 v[100:103], v185, s[20:23], s47 offen sc1
    s_nop 1
    v_max_f32_dpp v18, v16, v16 quad_perm:[1,0,3,2] row_mask:0xf bank_mask:0xf
    s_nop 1
    v_max_f32_dpp v18, v18, v18 quad_perm:[2,3,0,1] row_mask:0xf bank_mask:0xf
    s_nop 1
    v_max_f32_dpp v18, v18, v18 row_half_mirror row_mask:0xf bank_mask:0xf
    s_nop 1
    v_max_f32_dpp v18, v18, v18 row_ror:8 row_mask:0xf bank_mask:0xf
    v_mov_b32 v19, v18
    s_nop 1
    v_permlane16_swap_b32 v18, v19
    v_max_f32 v18, v18, v19
    v_mov_b32 v19, v18
    s_nop 1
    v_permlane32_swap_b32 v18, v19
    v_max_f32 v18, v18, v19
    v_sub_f32 v16, v16, v18
    v_exp_f32 v16, v16
    v_mov_b32_dpp v20, v17 quad_perm:[0,0,0,0] row_mask:0xf bank_mask:0xf
    v_mov_b32_dpp v21, v17 quad_perm:[1,1,1,1] row_mask:0xf bank_mask:0xf
    v_mov_b32_dpp v22, v17 quad_perm:[2,2,2,2] row_mask:0xf bank_mask:0xf
    v_mov_b32_dpp v23, v17 quad_perm:[3,3,3,3] row_mask:0xf bank_mask:0xf
    s_nop 1
    v_add_f32_dpp v18, v16, v16 quad_perm:[1,0,3,2] row_mask:0xf bank_mask:0xf
    s_nop 1
    v_add_f32_dpp v18, v18, v18 quad_perm:[2,3,0,1] row_mask:0xf bank_mask:0xf
    s_nop 1
    v_add_f32_dpp v18, v18, v18 row_half_mirror row_mask:0xf bank_mask:0xf
    s_nop 1
    v_add_f32_dpp v18, v18, v18 row_ror:8 row_mask:0xf bank_mask:0xf
    v_mov_b32 v19, v18
    s_nop 1
    v_permlane16_swap_b32 v18, v19
    v_add_f32 v18, v18, v19
    v_mov_b32 v19, v18
    s_nop 1
    v_permlane32_swap_b32 v18, v19
    v_add_f32 v18, v18, v19
    v_rcp_f32 v18, v18
    v_lshrrev_b32 v20, v196, v20
    v_lshrrev_b32 v21, v196, v21
    v_lshrrev_b32 v22, v196, v22
    v_lshrrev_b32 v23, v196, v23
    v_mul_f32 v16, v16, v18
    v_and_b32 v164, 1, v20
    v_bfe_u32 v165, v20, 4, 1
    v_and_b32 v166, 1, v21
    v_bfe_u32 v167, v21, 4, 1
    v_and_b32 v168, 1, v22
    v_bfe_u32 v169, v22, 4, 1
    v_and_b32 v170, 1, v23
    v_bfe_u32 v171, v23, 4, 1
    v_mov_b32_dpp v160, v16 quad_perm:[0,0,0,0] row_mask:0xf bank_mask:0xf
    v_mov_b32_dpp v161, v16 quad_perm:[1,1,1,1] row_mask:0xf bank_mask:0xf
    v_mov_b32_dpp v162, v16 quad_perm:[2,2,2,2] row_mask:0xf bank_mask:0xf
    v_mov_b32_dpp v163, v16 quad_perm:[3,3,3,3] row_mask:0xf bank_mask:0xf
    s_mov_b32 s60, 0xffff0000
    s_mov_b32 s61, 0x8000
    s_waitcnt vmcnt(3)
    v_xor_b32 v88, v164, v88
    v_xor_b32 v90, v165, v90
    v_bitop3_b32 v24, v88, v90, 1 bitop3:0xa8
    v_cmp_ne_u32 s[64:65], 0, v24
    s_waitcnt vmcnt(2)
    v_xor_b32 v92, v166, v92
    v_xor_b32 v94, v167, v94
    v_bitop3_b32 v25, v92, v94, 1 bitop3:0xa8
    v_cmp_ne_u32 s[66:67], 0, v25
    s_waitcnt vmcnt(1)
    v_xor_b32 v96, v168, v96
    v_xor_b32 v98, v169, v98
    v_bitop3_b32 v26, v96, v98, 1 bitop3:0xa8
    v_cmp_ne_u32 s[68:69], 0, v26
    s_waitcnt vmcnt(0)
    v_xor_b32 v100, v170, v100
    v_xor_b32 v102, v171, v102
    v_bitop3_b32 v27, v100, v102, 1 bitop3:0xa8
    v_cmp_ne_u32 s[70:71], 0, v27
    s_or_b64 s[84:85], s[64:65], s[66:67]
    s_or_b64 s[86:87], s[68:69], s[70:71]
    s_or_b64 vcc, s[84:85], s[86:87]
    s_cbranch_scc0 L_m3
    s_and_b64 exec, s[64:65], -1
    s_cbranch_scc0 L_m0
    buffer_load_dwordx4 v[88:91], v185, s[20:23], s44 offen sc1
L_m0:
    s_and_b64 exec, s[66:67], -1
    s_cbranch_scc0 L_m1
    buffer_load_dwordx4 v[92:95], v185, s[20:23], s45 offen sc1
L_m1:
    s_and_b64 exec, s[68:69], -1
    s_cbranch_scc0 L_m2
    buffer_load_dwordx4 v[96:99], v185, s[20:23], s46 offen sc1
L_m2:
    s_and_b64 exec, s[70:71], -1
    s_cbranch_scc0 L_m3
    buffer_load_dwordx4 v[100:103], v185, s[20:23], s47 offen sc1
L_m3:
    s_not_b64 exec, s[64:65]
    v_lshl_or_b32 v120, v88, 16, s61
    v_and_b32 v121, s60, v88
    v_lshlrev_b32 v122, 16, v89
    v_and_b32 v123, s60, v89
    v_lshl_or_b32 v124, v90, 16, s61
    v_and_b32 v125, s60, v90
    v_lshlrev_b32 v126, 16, v91
    v_and_b32 v127, s60, v91
    v_pk_mul_f32 v[120:121], v[120:121], v[160:161] op_sel:[0,0] op_sel_hi:[1,0]
    v_pk_mul_f32 v[122:123], v[122:123], v[160:161] op_sel:[0,0] op_sel_hi:[1,0]
    v_pk_mul_f32 v[124:125], v[124:125], v[160:161] op_sel:[0,0] op_sel_hi:[1,0]
    v_pk_mul_f32 v[126:127], v[126:127], v[160:161] op_sel:[0,0] op_sel_hi:[1,0]
    s_not_b64 exec, s[66:67]
    v_lshl_or_b32 v128, v92, 16, s61
    v_and_b32 v129, s60, v92
    v_lshlrev_b32 v130, 16, v93
    v_and_b32 v131, s60, v93
    v_lshl_or_b32 v132, v94, 16, s61
    v_and_b32 v133, s60, v94
    v_lshlrev_b32 v134, 16, v95
    v_and_b32 v135, s60, v95
    s_not_b64 exec, s[68:69]
    v_lshl_or_b32 v136, v96, 16, s61
    v_and_b32 v137, s60, v96
    v_lshlrev_b32 v138, 16, v97
    v_and_b32 v139, s60, v97
    v_lshl_or_b32 v140, v98, 16, s61
    v_and_b32 v141, s60, v98
    v_lshlrev_b32 v142, 16, v99
    v_and_b32 v143, s60, v99
    s_not_b64 exec, s[70:71]
    v_lshl_or_b32 v144, v100, 16, s61
    v_and_b32 v145, s60, v100
    v_lshlrev_b32 v146, 16, v101
    v_and_b32 v147, s60, v101
    v_lshl_or_b32 v148, v102, 16, s61
    v_and_b32 v149, s60, v102
    v_lshlrev_b32 v150, 16, v103
    v_and_b32 v151, s60, v103
    s_cbranch_vccz L_red
L_again:
    s_sub_u32 s96, s96, 1
    s_cbranch_scc1 L_end
    s_waitcnt vmcnt(0)
    s_and_b64 exec, s[64:65], -1
    s_cbranch_scc0 L_n0
    v_xor_b32 v88, v164, v88
    v_xor_b32 v90, v165, v90
    v_bitop3_b32 v24, v88, v90, 1 bitop3:0xa8
    v_cmp_ne_u32 vcc, 0, v24
    s_and_b64 exec, vcc, -1
    s_cbranch_scc0 L_o0
    buffer_load_dwordx4 v[88:91], v185, s[20:23], s44 offen sc1
L_o0:
    s_andn2_b64 exec, s[64:65], vcc
    s_mov_b64 s[64:65], vcc
    s_cbranch_scc0 L_n0
    v_lshl_or_b32 v120, v88, 16, s61
    v_and_b32 v121, s60, v88
    v_lshlrev_b32 v122, 16, v89
    v_and_b32 v123, s60, v89
    v_lshl_or_b32 v124, v90, 16, s61
    v_and_b32 v125, s60, v90
    v_lshlrev_b32 v126, 16, v91
    v_and_b32 v127, s60, v91
    v_pk_mul_f32 v[120:121], v[120:121], v[160:161] op_sel:[0,0] op_sel_hi:[1,0]
    v_pk_mul_f32 v[122:123], v[122:123], v[160:161] op_sel:[0,0] op_sel_hi:[1,0]
    v_pk_mul_f32 v[124:125], v[124:125], v[160:161] op_sel:[0,0] op_sel_hi:[1,0]
    v_pk_mul_f32 v[126:127], v[126:127], v[160:161] op_sel:[0,0] op_sel_hi:[1,0]
L_n0:
    s_and_b64 exec, s[66:67], -1
    s_cbranch_scc0 L_n1
    v_xor_b32 v92, v166, v92
    v_xor_b32 v94, v167, v94
    v_bitop3_b32 v25, v92, v94, 1 bitop3:0xa8
    v_cmp_ne_u32 vcc, 0, v25
    s_and_b64 exec, vcc, -1
    s_cbranch_scc0 L_o1
    buffer_load_dwordx4 v[92:95], v185, s[20:23], s45 offen sc1
L_o1:
    s_andn2_b64 exec, s[66:67], vcc
    s_mov_b64 s[66:67], vcc
    s_cbranch_scc0 L_n1
    v_lshl_or_b32 v128, v92, 16, s61
    v_and_b32 v129, s60, v92
    v_lshlrev_b32 v130, 16, v93
    v_and_b32 v131, s60, v93
    v_lshl_or_b32 v132, v94, 16, s61
    v_and_b32 v133, s60, v94
    v_lshlrev_b32 v134, 16, v95
    v_and_b32 v135, s60, v95
L_n1:
    s_and_b64 exec, s[68:69], -1
    s_cbranch_scc0 L_n2
    v_xor_b32 v96, v168, v96
    v_xor_b32 v98, v169, v98
    v_bitop3_b32 v26, v96, v98, 1 bitop3:0xa8
    v_cmp_ne_u32 vcc, 0, v26
    s_and_b64 exec, vcc, -1
    s_cbranch_scc0 L_o2
    buffer_load_dwordx4 v[96:99], v185, s[20:23], s46 offen sc1
L_o2:
    s_andn2_b64 exec, s[68:69], vcc
    s_mov_b64 s[68:69], vcc
    s_cbranch_scc0 L_n2
    v_lshl_or_b32 v136, v96, 16, s61
    v_and_b32 v137, s60, v96
    v_lshlrev_b32 v138, 16, v97
    v_and_b32 v139, s60, v97
    v_lshl_or_b32 v140, v98, 16, s61
    v_and_b32 v141, s60, v98
    v_lshlrev_b32 v142, 16, v99
    v_and_b32 v143, s60, v99
L_n2:
    s_and_b64 exec, s[70:71], -1
    s_cbranch_scc0 L_n3
    v_xor_b32 v100, v170, v100
    v_xor_b32 v102, v171, v102
    v_bitop3_b32 v27, v100, v102, 1 bitop3:0xa8
    v_cmp_ne_u32 vcc, 0, v27
    s_and_b64 exec, vcc, -1
    s_cbranch_scc0 L_o3
    buffer_load_dwordx4 v[100:103], v185, s[20:23], s47 offen sc1
L_o3:
    s_andn2_b64 exec, s[70:71], vcc
    s_mov_b64 s[70:71], vcc
    s_cbranch_scc0 L_n3
    v_lshl_or_b32 v144, v100, 16, s61
    v_and_b32 v145, s60, v100
    v_lshlrev_b32 v146, 16, v101
    v_and_b32 v147, s60, v101
    v_lshl_or_b32 v148, v102, 16, s61
    v_and_b32 v149, s60, v102
    v_lshlrev_b32 v150, 16, v103
    v_and_b32 v151, s60, v103
L_n3:
    s_or_b64 s[84:85], s[64:65], s[66:67]
    s_or_b64 s[86:87], s[68:69], s[70:71]
    s_or_b64 vcc, s[84:85], s[86:87]
    s_cbranch_scc1 L_again
    s_mov_b64 exec, -1
L_red:
    v_pk_fma_f32 v[120:121], v[128:129], v[160:161], v[120:121] op_sel:[0,1,0] op_sel_hi:[1,1,1]
    v_pk_fma_f32 v[122:123], v[130:131], v[160:161], v[122:123] op_sel:[0,1,0] op_sel_hi:[1,1,1]
    v_pk_fma_f32 v[124:125], v[132:133], v[160:161], v[124:125] op_sel:[0,1,0] op_sel_hi:[1,1,1]
    v_pk_fma_f32 v[126:127], v[134:135], v[160:161], v[126:127] op_sel:[0,1,0] op_sel_hi:[1,1,1]
    v_pk_fma_f32 v[120:121], v[136:137], v[162:163], v[120:121] op_sel:[0,0,0] op_sel_hi:[1,0,1]
    v_pk_fma_f32 v[122:123], v[138:139], v[162:163], v[122:123] op_sel:[0,0,0] op_sel_hi:[1,0,1]
    v_pk_fma_f32 v[124:125], v[140:141], v[162:163], v[124:125] op_sel:[0,0,0] op_sel_hi:[1,0,1]
    v_pk_fma_f32 v[126:127], v[142:143], v[162:163], v[126:127] op_sel:[0,0,0] op_sel_hi:[1,0,1]
    v_pk_fma_f32 v[120:121], v[144:145], v[162:163], v[120:121] op_sel:[0,1,0] op_sel_hi:[1,1,1]
    v_pk_fma_f32 v[122:123], v[146:147], v[162:163], v[122:123] op_sel:[0,1,0] op_sel_hi:[1,1,1]
    v_pk_fma_f32 v[124:125], v[148:149], v[162:163], v[124:125] op_sel:[0,1,0] op_sel_hi:[1,1,1]
    v_pk_fma_f32 v[126:127], v[150:151], v[162:163], v[126:127] op_sel:[0,1,0] op_sel_hi:[1,1,1]
    s_nop 0
    v_permlane32_swap_b32 v120, v124
    v_permlane32_swap_b32 v121, v125
    v_permlane32_swap_b32 v122, v126
    v_permlane32_swap_b32 v123, v127
    v_pk_add_f32 v[120:121], v[120:121], v[124:125]
    v_pk_add_f32 v[122:123], v[122:123], v[126:127]
    s_nop 1
    v_permlane16_swap_b32 v120, v122
    v_permlane16_swap_b32 v121, v123
    v_add_f32 v120, v120, v122
    v_add_f32 v121, v121, v123
    s_nop 0
    v_add_f32_dpp v120, v120, v120 row_ror:8 row_mask:0xf bank_mask:0xf
    v_add_f32_dpp v121, v121, v121 row_ror:8 row_mask:0xf bank_mask:0xf
    s_nop 0
    v_add_f32_dpp v120, v120, v120 row_ror:4 row_mask:0xf bank_mask:0xf
    v_add_f32_dpp v121, v121, v121 row_ror:4 row_mask:0xf bank_mask:0xf
    s_mov_b32 exec_lo, 0x000f000f
    s_mov_b32 exec_hi, 0x000f000f
    v_cvt_pk_bf16_f32 v120, v120, v121
    global_store_dword v187, v120, s[14:15]
L_end:
    s_endpgm
L_reset:
    s_lshl_b32 s37, s30, 13
    s_mul_i32 s36, s36, 8192
    s_add_u32 s36, s36, s37
    s_add_u32 s36, s36, 1051648
    v_lshl_add_u32 v240, v0, 4, s36
    v_mov_b32 v244, -1
    v_mov_b32 v245, -1
    v_mov_b32 v246, -1
    v_mov_b32 v247, -1
    global_store_dwordx4 v240, v[244:247], s[18:19] offset:-4096 sc1
    global_store_dwordx4 v240, v[244:247], s[18:19] offset:-3072 sc1
    global_store_dwordx4 v240, v[244:247], s[18:19] offset:-2048 sc1
    global_store_dwordx4 v240, v[244:247], s[18:19] offset:-1024 sc1
    global_store_dwordx4 v240, v[244:247], s[18:19] offset:0 sc1
    global_store_dwordx4 v240, v[244:247], s[18:19] offset:1024 sc1
    global_store_dwordx4 v240, v[244:247], s[18:19] offset:2048 sc1
    global_store_dwordx4 v240, v[244:247], s[18:19] offset:3072 sc1
    s_branch L_resetd
L_cntspin:
    s_sub_u32 s96, s96, 1
    s_cbranch_scc1 L_end
    s_lshl_b32 s36, s30, 6
    v_and_b32 v255, 0, v1
    v_lshl_add_u32 v255, v255, 2, s36
    global_load_dword v255, v255, s[16:17] sc1
    s_waitcnt vmcnt(0)
    v_cmp_eq_u32 s[84:85], 0, v255
    s_cmp_lg_u64 s[84:85], 0
    s_cbranch_scc1 L_cntspin
    s_branch L_cntok
L_ctx0:
    s_mov_b32 exec_lo, s42
    s_mov_b32 exec_hi, s42
    v_accvgpr_write_b32 a0, 0
    v_accvgpr_write_b32 a1, 0
    v_accvgpr_write_b32 a2, 0
    v_accvgpr_write_b32 a3, 0
    v_accvgpr_write_b32 a4, 0
    v_accvgpr_write_b32 a5, 0
    v_accvgpr_write_b32 a6, 0
    v_accvgpr_write_b32 a7, 0
    v_accvgpr_write_b32 a8, 0
    v_accvgpr_write_b32 a9, 0
    v_accvgpr_write_b32 a10, 0
    v_accvgpr_write_b32 a11, 0
    v_accvgpr_write_b32 a12, 0
    v_accvgpr_write_b32 a13, 0
    v_accvgpr_write_b32 a14, 0
    v_accvgpr_write_b32 a15, 0
    s_mov_b64 exec, -1
    s_branch L_ctxok
L_more:
    s_waitcnt lgkmcnt(0)
    s_barrier
    s_mov_b32 s33, 1
    s_cmp_eq_u32 s30, 1
    s_cselect_b64 vcc, -1, 0
    s_sub_u32 s32, s32, 40
    v_add_u32 v16, 40, v1
    v_cmp_gt_u32 s[84:85], 64, v16
    v_lshlrev_b32 v16, 2, v16
    ds_bpermute_b32 v17, v16, v252
    v_mov_b32 v18, 0x40000000
    s_waitcnt lgkmcnt(0)
    v_cndmask_b32 v252, v18, v17, s[84:85]
    v_and_b32 v255, 0xffffc000, v252
    s_mov_b32 m0, s41
    v_readlane_b32 s44, v255, 0
    v_readlane_b32 s45, v255, 1
    v_readlane_b32 s46, v255, 2
    v_readlane_b32 s47, v255, 3
    v_readlane_b32 s48, v255, 4
    v_readlane_b32 s49, v255, 5
    v_readlane_b32 s50, v255, 6
    v_readlane_b32 s51, v255, 7
    v_readlane_b32 s52, v255, 8
    v_readlane_b32 s53, v255, 9
    v_readlane_b32 s54, v255, 10
    v_readlane_b32 s55, v255, 11
    v_readlane_b32 s56, v255, 12
    v_readlane_b32 s57, v255, 13
    v_readlane_b32 s58, v255, 14
    v_readlane_b32 s59, v255, 15
    s_nop 4
    s_nop 0
    buffer_load_dwordx4 v2, s[20:23], s44 offen nt lds
    s_add_u32 m0, s41, 1024
    s_nop 0
    buffer_load_dwordx4 v3, s[20:23], s45 offen nt lds
    s_add_u32 m0, s41, 2048
    s_nop 0
    buffer_load_dwordx4 v4, s[20:23], s46 offen nt lds
    s_add_u32 m0, s41, 3072
    s_nop 0
    buffer_load_dwordx4 v5, s[20:23], s47 offen nt lds
    s_add_u32 m0, s41, 4096
    s_nop 0
    buffer_load_dwordx4 v2, s[20:23], s48 offen nt lds
    s_add_u32 m0, s41, 5120
    s_nop 0
    buffer_load_dwordx4 v3, s[20:23], s49 offen nt lds
    s_add_u32 m0, s41, 6144
    s_nop 0
    buffer_load_dwordx4 v4, s[20:23], s50 offen nt lds
    s_add_u32 m0, s41, 7168
    s_nop 0
    buffer_load_dwordx4 v5, s[20:23], s51 offen nt lds
    s_add_u32 m0, s41, 8192
    s_nop 0
    buffer_load_dwordx4 v2, s[20:23], s52 offen nt lds
    s_add_u32 m0, s41, 9216
    s_nop 0
    buffer_load_dwordx4 v3, s[20:23], s53 offen nt lds
    s_add_u32 m0, s41, 10240
    s_nop 0
    buffer_load_dwordx4 v4, s[20:23], s54 offen nt lds
    s_add_u32 m0, s41, 11264
    s_nop 0
    buffer_load_dwordx4 v5, s[20:23], s55 offen nt lds
    s_add_u32 m0, s41, 12288
    s_nop 0
    buffer_load_dwordx4 v2, s[20:23], s56 offen nt lds
    s_add_u32 m0, s41, 13312
    s_nop 0
    buffer_load_dwordx4 v3, s[20:23], s57 offen nt lds
    s_branch L_body
L_resc:
    v_sub_f32 v236, v14, v253
    v_mul_f32 v236, s40, v236
    v_exp_f32 v236, v236
    s_nop 0
    v_accvgpr_read_b32 v237, a48
    v_mul_f32 v237, v237, v236
    v_accvgpr_write_b32 a48, v237
    v_accvgpr_read_b32 v237, a49
    v_mul_f32 v237, v237, v236
    v_accvgpr_write_b32 a49, v237
    v_accvgpr_read_b32 v237, a50
    v_mul_f32 v237, v237, v236
    v_accvgpr_write_b32 a50, v237
    v_accvgpr_read_b32 v237, a51
    v_mul_f32 v237, v237, v236
    v_accvgpr_write_b32 a51, v237
    v_accvgpr_read_b32 v237, a52
    v_mul_f32 v237, v237, v236
    v_accvgpr_write_b32 a52, v237
    v_accvgpr_read_b32 v237, a53
    v_mul_f32 v237, v237, v236
    v_accvgpr_write_b32 a53, v237
    v_accvgpr_read_b32 v237, a54
    v_mul_f32 v237, v237, v236
    v_accvgpr_write_b32 a54, v237
    v_accvgpr_read_b32 v237, a55
    v_mul_f32 v237, v237, v236
    v_accvgpr_write_b32 a55, v237
    v_accvgpr_read_b32 v237, a56
    v_mul_f32 v237, v237, v236
    v_accvgpr_write_b32 a56, v237
    v_accvgpr_read_b32 v237, a57
    v_mul_f32 v237, v237, v236
    v_accvgpr_write_b32 a57, v237
    v_accvgpr_read_b32 v237, a58
    v_mul_f32 v237, v237, v236
    v_accvgpr_write_b32 a58, v237
    v_accvgpr_read_b32 v237, a59
    v_mul_f32 v237, v237, v236
    v_accvgpr_write_b32 a59, v237
    v_accvgpr_read_b32 v237, a60
    v_mul_f32 v237, v237, v236
    v_accvgpr_write_b32 a60, v237
    v_accvgpr_read_b32 v237, a61
    v_mul_f32 v237, v237, v236
    v_accvgpr_write_b32 a61, v237
    v_accvgpr_read_b32 v237, a62
    v_mul_f32 v237, v237, v236
    v_accvgpr_write_b32 a62, v237
    v_accvgpr_read_b32 v237, a63
    v_mul_f32 v237, v237, v236
    v_accvgpr_write_b32 a63, v237
    v_accvgpr_read_b32 v237, a64
    v_mul_f32 v237, v237, v236
    v_accvgpr_write_b32 a64, v237
    v_accvgpr_read_b32 v237, a65
    v_mul_f32 v237, v237, v236
    v_accvgpr_write_b32 a65, v237
    v_accvgpr_read_b32 v237, a66
    v_mul_f32 v237, v237, v236
    v_accvgpr_write_b32 a66, v237
    v_accvgpr_read_b32 v237, a67
    v_mul_f32 v237, v237, v236
    v_accvgpr_write_b32 a67, v237
    v_accvgpr_read_b32 v237, a68
    v_mul_f32 v237, v237, v236
    v_accvgpr_write_b32 a68, v237
    v_accvgpr_read_b32 v237, a69
    v_mul_f32 v237, v237, v236
    v_accvgpr_write_b32 a69, v237
    v_accvgpr_read_b32 v237, a70
    v_mul_f32 v237, v237, v236
    v_accvgpr_write_b32 a70, v237
    v_accvgpr_read_b32 v237, a71
    v_mul_f32 v237, v237, v236
    v_accvgpr_write_b32 a71, v237
    v_accvgpr_read_b32 v237, a72
    v_mul_f32 v237, v237, v236
    v_accvgpr_write_b32 a72, v237
    v_accvgpr_read_b32 v237, a73
    v_mul_f32 v237, v237, v236
    v_accvgpr_write_b32 a73, v237
    v_accvgpr_read_b32 v237, a74
    v_mul_f32 v237, v237, v236
    v_accvgpr_write_b32 a74, v237
    v_accvgpr_read_b32 v237, a75
    v_mul_f32 v237, v237, v236
    v_accvgpr_write_b32 a75, v237
    v_accvgpr_read_b32 v237, a76
    v_mul_f32 v237, v237, v236
    v_accvgpr_write_b32 a76, v237
    v_accvgpr_read_b32 v237, a77
    v_mul_f32 v237, v237, v236
    v_accvgpr_write_b32 a77, v237
    v_accvgpr_read_b32 v237, a78
    v_mul_f32 v237, v237, v236
    v_accvgpr_write_b32 a78, v237
    v_accvgpr_read_b32 v237, a79
    v_mul_f32 v237, v237, v236
    v_accvgpr_write_b32 a79, v237
    v_accvgpr_read_b32 v237, a80
    v_mul_f32 v237, v237, v236
    v_accvgpr_write_b32 a80, v237
    v_accvgpr_read_b32 v237, a81
    v_mul_f32 v237, v237, v236
    v_accvgpr_write_b32 a81, v237
    v_accvgpr_read_b32 v237, a82
    v_mul_f32 v237, v237, v236
    v_accvgpr_write_b32 a82, v237
    v_accvgpr_read_b32 v237, a83
    v_mul_f32 v237, v237, v236
    v_accvgpr_write_b32 a83, v237
    s_branch L_noresc
L_codeend:
.section .rodata,"a"
.p2align 6
.amdhsa_kernel standalone__paged_block_table_kv_radixattention__decode_kernel
  .amdhsa_next_free_vgpr 352
  .amdhsa_next_free_sgpr 102
  .amdhsa_accum_offset 256
  .amdhsa_group_segment_fixed_size 0
  .amdhsa_kernarg_size 64
  .amdhsa_user_sgpr_count 2
  .amdhsa_user_sgpr_kernarg_segment_ptr 1
  .amdhsa_system_sgpr_workgroup_id_x 1
  .amdhsa_float_denorm_mode_32 3
.end_amdhsa_kernel
```
